```python
import torch

def _softmax(x, axis=-1):
    return torch.softmax(x, dim=axis)
def _gelu(x):
    return torch.nn.functional.gelu(x, approximate="tanh")
def _silu(x):
    return torch.nn.functional.silu(x)
def _sigmoid(x):
    return torch.sigmoid(x)
def _layernorm(x, axis=-1, eps=1e-5):
    m = x.mean(dim=axis, keepdim=True)
    v = x.var(dim=axis, keepdim=True, unbiased=False)
    return (x - m) / torch.sqrt(v + eps)
def _scatter_add(tgt, idx, src, axis=0):
    return tgt.clone().index_add_(axis, idx, src)
def _segment_sum(src, seg, n):
    out = torch.zeros((n,) + src.shape[1:], dtype=src.dtype)
    return out.index_add_(0, seg, src)
def _pad(x, pw):
    flat = tuple(v for pair in reversed(pw) for v in pair)
    return torch.nn.functional.pad(x, flat)

kernel_name = 'interleave_layers__ssm_conv_h3__ssm_conv_s4__prompt'

def setup_inputs():

    _w = (lambda a: (lambda t: t.to(torch.bfloat16) if t.is_floating_point() else t)(torch.as_tensor(a)))
    def _A_setup():
        B, S, D = 1, 2048, 512
        ks = 4
        return {
            "q": _w((lambda *s: torch.randn(*s, dtype=torch.bfloat16) * 0.05)(B, S, D)),
            "k": _w((lambda *s: torch.randn(*s, dtype=torch.bfloat16) * 0.4)(B, S, D)),
            "v": _w((lambda *s: torch.randn(*s, dtype=torch.bfloat16) * 0.4)(B, S, D)),
            "shift_k": _w((lambda *s: torch.randn(*s, dtype=torch.bfloat16) * 0.4)(D, ks) * 0.5),
            "ssm_k": _w((lambda *s: torch.randn(*s, dtype=torch.bfloat16) * 0.4)(D, S) * (1.0 / S ** 0.5)),
            "ssm_D": _w((lambda *s: torch.randn(*s, dtype=torch.bfloat16) * 0.4)(D)),
        }
    _A_in = _A_setup()

    def _B_setup():
        B, L, D, N = 1, 2048, 512, 128
        A_re = -(lambda _x: torch.exp(torch.as_tensor(_x)))((lambda *s: torch.randn(*s, dtype=torch.bfloat16) * 6.4)(D, N))
        A_im = torch.pi * (lambda *s: torch.randn(*s, dtype=torch.bfloat16) * 0.05)(D, N)
        B_re = (lambda *s: torch.randn(*s, dtype=torch.bfloat16) * 0.1)(D, N)
        B_im = (lambda *s: torch.randn(*s, dtype=torch.bfloat16) * 0.1)(D, N)
        C_re = (lambda *s: torch.randn(*s, dtype=torch.bfloat16) * 0.1)(D, N)
        C_im = (lambda *s: torch.randn(*s, dtype=torch.bfloat16) * 0.1)(D, N)
        log_dt = (lambda *s: torch.randn(*s, dtype=torch.bfloat16) * 0.05)(D) * 0.5 - 4.0
        Dskip = (lambda *s: torch.randn(*s, dtype=torch.bfloat16) * 0.05)(D)
        return {
            "u": _w((lambda *s: torch.randn(*s, dtype=torch.bfloat16) * 0.05)(B, L, D)),
            "A_re": _w(A_re),
            "A_im": _w(A_im),
            "B_re": _w(B_re),
            "B_im": _w(B_im),
            "C_re": _w(C_re),
            "C_im": _w(C_im),
            "log_dt": _w(log_dt),
            "Dskip": _w(Dskip),
        }
    _B_in = _B_setup()

    return {
        "A_q": _A_in["q"],
        "A_k": _A_in["k"],
        "A_v": _A_in["v"],
        "A_shift_k": _A_in["shift_k"],
        "A_ssm_k": _A_in["ssm_k"],
        "A_ssm_D": _A_in["ssm_D"],
        "B_u": _B_in["u"],
        "B_A_re": _B_in["A_re"],
        "B_A_im": _B_in["A_im"],
        "B_B_re": _B_in["B_re"],
        "B_B_im": _B_in["B_im"],
        "B_C_re": _B_in["C_re"],
        "B_C_im": _B_in["C_im"],
        "B_log_dt": _B_in["log_dt"],
        "B_Dskip": _B_in["Dskip"],
    }

def reference(A_q, A_k, A_v, A_shift_k, A_ssm_k, A_ssm_D, B_u, B_A_re, B_A_im, B_B_re, B_B_im, B_C_re, B_C_im, B_log_dt, B_Dskip):
    def _A_ref(q, k, v, shift_k, ssm_k, ssm_D):
        B, S, D = q.shape
        ks = shift_k.shape[-1]
        k_pad = _pad(k, ((0, 0), (ks - 1, 0), (0, 0)))
        k_shift = torch.zeros_like(k)
        for t in range(ks):
            k_shift = k_shift + k_pad[:, t:t + S, :] * shift_k[:, ks - 1 - t][None, None, :]
        kv = k_shift * v
        L = 2 * S
        kv_pad = _pad(kv, ((0, 0), (0, S), (0, 0)))
        kf_pad = _pad(ssm_k, ((0, 0), (0, S)))
        kv_f = (lambda x, axes=(-2,-1): torch.fft.rfft2(x.float(), dim=axes))(kv_pad[:, None, :, :], axes=(1, 2))
        kf_f = (lambda x, axes=(-2,-1): torch.fft.rfft2(x.float(), dim=axes))(kf_pad[:, None, :], axes=(1, 2))
        kf_f = (lambda x, *d: x.permute(*d))(kf_f, 1, 2, 0)
        y_f = kv_f * kf_f[None, :, :, :]
        y = (lambda x, s, axes=(-2,-1): torch.fft.irfft2(x, s=s, dim=axes).to(torch.bfloat16))(y_f, (1, L), axes=(1, 2))[:, 0, :S, :]
        y = y + kv * ssm_D[None, None, :]
        return q * y

    def _B_ref(u, A_re, A_im, B_re, B_im, C_re, C_im, log_dt, Dskip):
        Bsz, L, D = u.shape
        dt = torch.exp(log_dt)[:, None]
        A = A_re + 1j * A_im
        Bc = B_re + 1j * B_im
        Cc = C_re + 1j * C_im
        logdA = dt * A
        dB = dt * Bc
        l = (lambda x, dt: x.to(dt))(torch.arange(L), A_re.dtype)
        P = torch.exp(logdA[:, :, None] * l[None, None, :])
        K = torch.einsum("dn,dnl,dn->dl", Cc, P, dB).real
        L2 = 2 * L
        Kp = _pad(K, ((0, 0), (0, L)))
        up = (lambda x, *d: x.permute(*d))(u, 0, 2, 1)
        up = _pad(up, ((0, 0), (0, 0), (0, L)))
        Kf = (lambda x, axes=(-2,-1): torch.fft.rfft2(x.float(), dim=axes))(Kp[:, None, :], axes=(-2, -1))
        Uf = (lambda x, axes=(-2,-1): torch.fft.rfft2(x.float(), dim=axes))(up[:, :, None, :], axes=(-2, -1))
        Yf = Uf * Kf[None, :, :, :]
        y = (lambda x, s, axes=(-2,-1): torch.fft.irfft2(x, s=s, dim=axes).to(torch.bfloat16))(Yf, (1, L2), axes=(-2, -1))[:, :, 0, :L]
        y = (lambda x, *d: x.permute(*d))(y, 0, 2, 1) + u * Dskip[None, None, :]
        return y

    x = A_q
    x = x + _A_ref(_layernorm(x, axis=-1), A_k, A_v, A_shift_k, A_ssm_k, A_ssm_D)
    x = x + _B_ref(_layernorm(x, axis=-1), B_A_re, B_A_im, B_B_re, B_B_im, B_C_re, B_C_im, B_log_dt, B_Dskip)
    x = x + _A_ref(_layernorm(x, axis=-1), A_k, A_v, A_shift_k, A_ssm_k, A_ssm_D)
    x = x + _B_ref(_layernorm(x, axis=-1), B_A_re, B_A_im, B_B_re, B_B_im, B_C_re, B_C_im, B_log_dt, B_Dskip)
    return x
```

```asm
; @launch grid=(256,1,1) block=(256,1,1) lds=156032
.amdgcn_target "amdgcn-amd-amdhsa--gfx950"
.text
.globl interleave_layers__ssm_conv_h3__ssm_conv_s4__prompt_kernel
.p2align 8
.type interleave_layers__ssm_conv_h3__ssm_conv_s4__prompt_kernel,@function
interleave_layers__ssm_conv_h3__ssm_conv_s4__prompt_kernel:
    s_cmp_ge_u32 s2, 256
    s_cbranch_scc1 L_exit
    s_load_dwordx16 s[16:31], s[0:1], 0
    s_load_dwordx16 s[32:47], s[0:1], 64
    s_load_dwordx4 s[48:51], s[0:1], 128
    s_lshr_b32 s7, s2, 3
    s_min_u32 s7, s7, 16
    s_lshl_b32 s7, s7, 3
    s_load_dwordx2 s[88:89], s[0:1], s7
    s_getpc_b64 s[56:57]
L_pc:
    s_bfe_u32 s7, s2, 0x30003
    s_mul_i32 s7, s7, 32
    v_min_u32 v12, 31, v0
    v_add_u32 v12, s7, v12
    v_lshlrev_b32 v12, 7, v12
    v_min_u32 v12, L_end-L_pc, v12
    global_load_dword v160, v12, s[56:57]
    s_and_b32 s7, s2, 7
    s_lshr_b32 s56, s2, 3
    s_lshl_b32 s3, s7, 5
    s_add_u32 s3, s3, s56
    s_lshr_b32 s6, s56, 4
    s_lshl_b32 s4, s6, 7
    s_lshl_b32 s7, s7, 4
    s_add_u32 s4, s4, s7
    s_and_b32 s56, s56, 15
    s_add_u32 s4, s4, s56
    s_lshl_b32 s78, s4, 5
    s_lshl_b32 s79, s4, 13
    s_lshl_b32 s80, s3, 5
    s_lshl_b32 s81, s3, 13
    v_lshrrev_b32 v12, 6, v0
    v_lshlrev_b32 v1, 4, v0
    v_readfirstlane_b32 s5, v12
    v_add_u32 v11, 4096, v1
    v_and_b32 v13, 63, v0
    v_lshlrev_b32 v148, 4, v13
    s_lshl_b32 s56, s5, 10
    s_add_u32 s57, s56, s79
    s_sub_u32 s58, s57, 4096
    v_add_u32 v149, s58, v148
    v_add_u32 v150, s57, v148
    s_mul_i32 s67, s5, 1088
    v_add_u32 v151, 4096, v150
    v_lshlrev_b32_e64 v152, 3, v0
    s_mov_b32 s14, 13631488
    s_mov_b32 s15, 0x00020000
    s_mov_b32 s10, 2097152
    s_mov_b32 s11, 0x00020000
    v_lshlrev_b32 v153, 1, v0
    s_lshl_b32 s56, s3, 9
    v_add_u32 v154, s56, v153
    v_lshrrev_b32 v155, 7, v0
    v_lshl_add_u32 v155, s3, 1, v155
    v_lshlrev_b32 v155, 1, v155
    s_add_u32 m0, s67, 122688
    v_mov_b32 v12, -1
    v_mov_b32 v13, -1
    v_mov_b32 v14, -1
    v_mov_b32 v15, -1
    s_waitcnt lgkmcnt(0)
    s_mov_b32 s12, s50
    s_mov_b32 s13, s51
    s_mov_b32 s8, s18
    s_mov_b32 s9, s19
    s_add_u32 s82, s79, 0
    buffer_store_dwordx4 v[12:15], v1, s[12:15], s82 offen sc1
    buffer_store_dwordx4 v[12:15], v11, s[12:15], s82 offen sc1
    buffer_load_dwordx4 v149, s[8:11], 0 offen  lds
    s_add_u32 m0, s67, 127040
    s_nop 0
    buffer_load_dwordx4 v150, s[8:11], 0 offen  lds
    s_add_u32 m0, s67, 131392
    s_nop 0
    buffer_load_dwordx4 v151, s[8:11], 0 offen  lds
    s_add_u32 m0, s67, 135744
    s_nop 0
    global_load_lds_dwordx4 v150, s[20:21]
    s_add_u32 m0, s67, 140096
    s_nop 0
    global_load_lds_dwordx4 v151, s[20:21]
    global_load_dwordx2 v[156:157], v152, s[22:23]
    global_load_dwordx2 v[158:159], v152, s[22:23] offset:2048
    v_add_u32 v161, s81, v1
    v_subrev_u32 v162, 8, v1
    v_max_i32 v162, 0, v162
    v_add_u32_e64 v162, s81, v162
    v_add_u32 v163, 4096, v161
    v_add_u32 v152, 4096, v162
    s_load_dword s68, s[88:89], 0
    s_mov_b32 s64, 0x00003f80
    s_mov_b32 s65, 0x3f800000
    s_mov_b32 s66, 0x3f803f80
    s_mov_b32 s69, 0x100000
    s_mov_b32 s83, 0x3b000000
    s_and_b32 s77, s5, 1
    s_mov_b32 s52, s48
    s_mov_b32 s53, s49
    s_mov_b32 s54, 256
    s_mov_b32 s55, 0x00020000
    v_lshrrev_b32 v12, 1, v0
    v_and_b32 v13, 1, v0
    v_lshlrev_b32_e64 v2, 13, v12
    v_lshl_add_u32 v2, v13, 4, v2
    v_add_u32 v3, 1048576, v2
    v_mul_u32_u24 v4, 10432, v13
    v_lshl_add_u32 v4, v12, 2, v4
    v_add_u32 v4, 128, v4
    v_add_u32 v130, 5256, v4
    s_lshr_b32 s56, s5, 1
    v_and_b32 v12, 15, v0
    v_bfe_u32 v13, v0, 4, 2
    s_mul_i32 s57, s56, 10432
    v_lshlrev_b32 v5, 3, v12
    v_lshl_add_u32 v5, v13, 4, v5
    s_add_u32 s57, s57, 5264
    v_add_u32 v5, s57, v5
    v_and_b32 v14, 1, v0
    v_mul_u32_u24 v14, 5256, v14
    v_sub_u32 v5, v5, v14
    v_and_b32 v14, 3, v0
    v_bfe_u32 v15, v0, 2, 2
    v_sub_u32 v14, v14, v15
    v_lshlrev_b32 v14, 3, v14
    v_lshlrev_b32 v15, 6, v13
    v_sub_u32 v14, v14, v15
    s_mul_i32 s57, s56, 16640
    s_add_u32 s57, s57, 89632
    v_add_u32 v6, s57, v14
    v_mul_u32_u24 v14, 80, v12
    v_lshl_add_u32 v14, v13, 4, v14
    v_and_b32 v15, 1, v13
    v_lshlrev_b32 v15, 3, v15
    v_sub_u32 v14, v14, v15
    s_mul_i32 s57, s77, 1280
    s_lshl_b32 s58, s56, 4
    s_add_u32 s57, s57, s58
    s_add_u32 s57, s57, 20864
    v_add_u32 v7, s57, v14
    v_lshrrev_b32 v14, 2, v0
    v_lshlrev_b32 v14, 4, v14
    v_add_u32_e64 v8, v14, v1
    v_add_u32 v8, 20864, v8
    v_bfe_u32 v12, v0, 2, 1
    v_bfe_u32 v13, v0, 4, 1
    v_bfe_u32 v14, v0, 5, 1
    v_lshlrev_b32_e64 v12, 7, v12
    v_lshl_add_u32 v12, v13, 6, v12
    v_lshl_add_u32 v12, v14, 5, v12
    v_bfe_u32 v13, v0, 3, 1
    v_lshl_add_u32 v12, v13, 4, v12
    s_lshl_b32 s57, s5, 2
    s_add_u32 s57, s57, 31232
    s_mov_b32 s59, s57
    v_add_u32 v9, s57, v12
    v_and_b32 v12, 7, v0
    v_lshlrev_b32 v12, 5, v12
    v_add_u32 v10, 31232, v12
    v_bfe_u32 v12, v0, 2, 2
    v_mul_u32_u24 v12, 1088, v12
    v_and_b32 v13, 3, v0
    v_lshlrev_b32 v13, 3, v13
    v_lshrrev_b32 v14, 4, v0
    v_lshlrev_b32 v14, 5, v14
    v_add3_u32 v131, v12, v13, v14
    v_add_u32 v131, 122688, v131
    s_waitcnt vmcnt(7)
    s_barrier
    s_cmp_eq_u32 s5, 0
    s_cbranch_scc1 L_arr1
    buffer_store_dword v12, v1, s[52:55], 0 offen offset:4080
L_arr1_ret:
    v_mov_b32 v104, 0
    v_mov_b32 v105, 0
    v_mov_b32 v106, 0
    v_mov_b32_e64 v107, 0
    v_bfe_u32 v12, v0, 4, 2
    v_mul_u32_u24 v12, 1280, v12
    v_bfe_u32 v13, v0, 6, 1
    v_mul_u32_u24 v13, 5248, v13
    v_lshrrev_b32 v14, 7, v0
    v_mul_u32_u24 v14, 10432, v14
    v_add3_u32 v12, v12, v13, v14
    v_and_b32 v14, 15, v0
    v_lshl_add_u32 v12, v14, 4, v12
    ds_write_b128 v12, v[104:107]
    v_bfe_u32 v12, v0, 1, 3
    v_mul_u32_u24 v12, 4160, v12
    v_and_b32_e64 v13, 1, v0
    v_lshl_add_u32 v12, v13, 4, v12
    v_add_u32 v12, 89408, v12
    ds_write_b128 v12, v[104:107]
    v_mul_u32_u24 v13, 5776, v13
    v_add_u32 v13, 144448, v13
    ds_write_b128 v13, v[104:107]
    v_lshlrev_b32 v12, 3, v0
    v_add_u32 v164, -4, v12
    v_add_u32 v165, -3, v12
    v_add_u32 v166, -2, v12
    v_add_u32 v167, -1, v12
    v_add_u32 v168, 0, v12
    v_add_u32 v169, 1, v12
    v_add_u32 v170, 2, v12
    v_add_u32 v171, 3, v12
    v_add_u32 v172, 4, v12
    v_add_u32 v173, 5, v12
    v_add_u32 v174, 6, v12
    v_add_u32 v175, 7, v12
    v_cvt_f32_i32 v164, v164
    v_cvt_f32_i32 v165, v165
    v_cvt_f32_i32 v166, v166
    v_cvt_f32_i32 v167, v167
    v_cvt_f32_i32 v168, v168
    v_cvt_f32_i32 v169, v169
    v_cvt_f32_i32 v170, v170
    v_cvt_f32_i32 v171, v171
    v_cvt_f32_i32 v172, v172
    v_cvt_f32_i32 v173, v173
    v_cvt_f32_i32 v174, v174
    v_cvt_f32_i32_e64 v175, v175
    v_cvt_pk_bf16_f32 v80, v164, v165
    v_cvt_pk_bf16_f32 v81, v166, v167
    v_cvt_pk_bf16_f32 v82, v168, v169
    v_cvt_pk_bf16_f32 v83, v170, v171
    v_cvt_pk_bf16_f32 v84, v172, v173
    v_cvt_pk_bf16_f32 v85, v174, v175
    v_lshlrev_b32 v164, 16, v80
    v_and_b32 v165, 0xffff0000, v80
    v_lshlrev_b32 v166, 16, v81
    v_and_b32 v167, 0xffff0000, v81
    v_lshlrev_b32 v168, 16, v82
    v_and_b32 v169, 0xffff0000, v82
    v_lshlrev_b32 v170, 16, v83
    v_and_b32 v171, 0xffff0000, v83
    v_lshlrev_b32 v172, 16, v84
    v_and_b32 v173, 0xffff0000, v84
    v_lshlrev_b32 v174, 16, v85
    v_and_b32 v175, 0xffff0000, v85
    v_cvt_i32_f32 v164, v164
    v_cvt_i32_f32 v165, v165
    v_cvt_i32_f32 v166, v166
    v_cvt_i32_f32 v167, v167
    v_cvt_i32_f32 v168, v168
    v_cvt_i32_f32 v169, v169
    v_cvt_i32_f32 v170, v170
    v_cvt_i32_f32 v171, v171
    v_cvt_i32_f32 v172, v172
    v_cvt_i32_f32 v173, v173
    v_cvt_i32_f32 v174, v174
    v_cvt_i32_f32 v175, v175
    s_mov_b32 s57, 144464
    v_ashrrev_i32 v64, 3, v164
    v_ashrrev_i32 v65, 3, v165
    v_ashrrev_i32 v66, 3, v166
    v_ashrrev_i32 v67, 3, v167
    v_ashrrev_i32 v68, 3, v168
    v_ashrrev_i32 v69, 3, v169
    v_ashrrev_i32 v70, 3, v170
    v_ashrrev_i32 v71, 3, v171
    v_ashrrev_i32 v72, 3, v172
    v_ashrrev_i32 v73, 3, v173
    v_ashrrev_i32 v74, 3, v174
    v_ashrrev_i32 v75, 3, v175
    v_lshl_add_u32 v164, v64, 1, v164
    v_lshl_add_u32 v165, v65, 1, v165
    v_lshl_add_u32 v166, v66, 1, v166
    v_lshl_add_u32 v167, v67, 1, v167
    v_lshl_add_u32 v168, v68, 1, v168
    v_lshl_add_u32 v169, v69, 1, v169
    v_lshl_add_u32 v170, v70, 1, v170
    v_lshl_add_u32 v171, v71, 1, v171
    v_lshl_add_u32 v172, v72, 1, v172
    v_lshl_add_u32 v173, v73, 1, v173
    v_lshl_add_u32 v174, v74, 1, v174
    v_lshl_add_u32 v175, v75, 1, v175
    v_lshl_add_u32 v164, v164, 1, s57
    v_lshl_add_u32 v165, v165, 1, s57
    v_lshl_add_u32 v166, v166, 1, s57
    v_lshl_add_u32 v167, v167, 1, s57
    v_lshl_add_u32 v168, v168, 1, s57
    v_lshl_add_u32 v169, v169, 1, s57
    v_lshl_add_u32 v170, v170, 1, s57
    v_lshl_add_u32 v171, v171, 1, s57
    v_lshl_add_u32 v172, v172, 1, s57
    v_lshl_add_u32 v173, v173, 1, s57
    v_lshl_add_u32 v174, v174, 1, s57
    v_lshl_add_u32 v175, v175, 1, s57
    v_mov_b32 v12, -1
    v_mov_b32 v13, -1
    v_mov_b32 v14, -1
    v_mov_b32 v15, -1
    s_cmp_eq_u32 s5, 0
    s_nop 0
    s_cselect_b32 s59, 67108864, s81
    s_add_u32 s82, s59, 2097152
    buffer_store_dwordx4 v[12:15], v1, s[12:15], s82 offen sc1
    buffer_store_dwordx4 v[12:15], v11, s[12:15], s82 offen sc1
    global_load_dwordx4 v[194:197], v161, s[24:25]
    global_load_dwordx2 v[192:193], v162, s[24:25]
    global_load_dwordx4 v[200:203], v163, s[24:25]
    global_load_dwordx2 v[198:199], v152, s[24:25]
    s_waitcnt vmcnt(7)
    s_barrier
    ds_read_b64_tr_b16 v[88:89], v131 offset:0
    ds_read_b64_tr_b16 v[90:91], v131 offset:4352
    ds_read_b64_tr_b16 v[92:93], v131 offset:8704
    ds_read_b64_tr_b16 v[94:95], v131 offset:512
    ds_read_b64_tr_b16 v[96:97], v131 offset:4864
    ds_read_b64_tr_b16 v[98:99], v131 offset:9216
    ds_read_b64_tr_b16 v[80:81], v131 offset:13056
    ds_read_b64_tr_b16 v[82:83], v131 offset:17408
    ds_read_b64_tr_b16 v[84:85], v131 offset:13568
    ds_read_b64_tr_b16 v[86:87], v131 offset:17920
    s_mov_b32 s57, 0x03020504
    v_alignbit_b32 v16, v157, v157, 16
    v_alignbit_b32 v17, v156, v156, 16
    v_and_b32 v18, 0xffff0000, v157
    v_and_b32 v20, 0xffff, v156
    v_perm_b32 v19, v157, v156, s57
    v_alignbit_b32 v21, v159, v159, 16
    v_alignbit_b32 v22, v158, v158, 16
    v_and_b32 v23, 0xffff0000, v159
    v_and_b32 v25, 0xffff, v158
    v_perm_b32 v24, v159, v158, s57
    s_waitcnt lgkmcnt(0)
    s_nop 0
    v_dot2_f32_bf16 v32, v88, v18, 0
    v_dot2_f32_bf16 v33, v89, v16, 0
    v_dot2_f32_bf16 v34, v89, v18, 0
    v_dot2_f32_bf16 v35, v90, v16, 0
    v_dot2_f32_bf16 v36, v90, v18, 0
    v_dot2_f32_bf16 v37, v91, v16, 0
    v_dot2_f32_bf16 v38, v91, v18, 0
    v_dot2_f32_bf16 v39, v92, v16, 0
    v_dot2_f32_bf16 v40, v94, v23, 0
    v_dot2_f32_bf16 v41, v95, v21, 0
    v_dot2_f32_bf16 v42, v95, v23, 0
    v_dot2_f32_bf16 v43, v96, v21, 0
    v_dot2_f32_bf16 v44, v96, v23, 0
    v_dot2_f32_bf16 v45, v97, v21, 0
    v_dot2_f32_bf16 v46, v97, v23, 0
    v_dot2_f32_bf16 v47, v98, v21, 0
    v_dot2_f32_bf16 v32, v89, v19, v32
    v_dot2_f32_bf16 v33, v90, v17, v33
    v_dot2_f32_bf16 v34, v90, v19, v34
    v_dot2_f32_bf16 v35, v91, v17, v35
    v_dot2_f32_bf16 v36, v91, v19, v36
    v_dot2_f32_bf16 v37, v92, v17, v37
    v_dot2_f32_bf16 v38, v92, v19, v38
    v_dot2_f32_bf16 v39, v93, v17, v39
    v_dot2_f32_bf16 v40, v95, v24, v40
    v_dot2_f32_bf16 v41, v96, v22, v41
    v_dot2_f32_bf16 v42, v96, v24, v42
    v_dot2_f32_bf16 v43, v97, v22, v43
    v_dot2_f32_bf16 v44, v97, v24, v44
    v_dot2_f32_bf16 v45, v98, v22, v45
    v_dot2_f32_bf16 v46, v98, v24, v46
    v_dot2_f32_bf16 v47, v99, v22, v47
    s_waitcnt lgkmcnt(0)
    v_dot2_f32_bf16 v32, v90, v20, v32
    v_lshlrev_b32 v48, 16, v80
    v_and_b32 v49, 0xffff0000, v80
    v_dot2_f32_bf16 v34, v91, v20, v34
    v_lshlrev_b32 v50, 16, v81
    v_and_b32 v51, 0xffff0000, v81
    v_dot2_f32_bf16 v36, v92, v20, v36
    v_lshlrev_b32 v52, 16, v82
    v_and_b32 v53, 0xffff0000, v82
    v_dot2_f32_bf16 v38, v93, v20, v38
    v_lshlrev_b32 v54, 16, v83
    v_and_b32 v55, 0xffff0000, v83
    v_dot2_f32_bf16 v40, v96, v25, v40
    v_lshlrev_b32 v56, 16, v84
    v_and_b32 v57, 0xffff0000, v84
    v_dot2_f32_bf16 v42, v97, v25, v42
    v_lshlrev_b32 v58, 16, v85
    v_and_b32 v59, 0xffff0000, v85
    v_dot2_f32_bf16 v44, v98, v25, v44
    v_lshlrev_b32 v60, 16, v86
    v_and_b32 v61, 0xffff0000, v86
    v_dot2_f32_bf16 v46, v99, v25, v46
    v_lshlrev_b32 v62, 16, v87
    v_and_b32 v63, 0xffff0000, v87
    v_mul_f32 v106, v33, v49
    v_mul_f32 v110, v35, v51
    v_mul_f32 v114, v37, v53
    v_mul_f32 v118, v39, v55
    v_mul_f32 v104, v32, v48
    v_mul_f32 v108, v34, v50
    v_mul_f32 v112, v36, v52
    v_mul_f32 v116, v38, v54
    v_mul_f32 v107, v41, v57
    v_mul_f32 v111, v43, v59
    v_mul_f32 v115, v45, v61
    v_mul_f32 v119, v47, v63
    v_mul_f32 v105, v40, v56
    v_mul_f32 v109, v42, v58
    v_mul_f32 v113, v44, v60
    v_mul_f32_e64 v117, v46, v62
    v_cvt_pk_bf16_f32 v88, v104, v112
    v_cvt_pk_bf16_f32 v89, v106, v114
    v_cvt_pk_bf16_f32 v90, v108, v116
    v_cvt_pk_bf16_f32 v91, v110, v118
    v_cvt_pk_bf16_f32 v92, v105, v113
    v_cvt_pk_bf16_f32 v93, v107, v115
    v_cvt_pk_bf16_f32 v94, v109, v117
    v_cvt_pk_bf16_f32 v95, v111, v119
    s_cmp_eq_u32 s5, 0
    s_cbranch_scc1 L_g0
    s_waitcnt vmcnt(4)
L_g0r:
    s_barrier
    buffer_store_dwordx4 v[88:91], v1, s[12:15], s79 offen sc1
    buffer_store_dwordx4 v[92:95], v11, s[12:15], s79 offen sc1
    s_add_u32 m0, s67, 31744
    v_and_b32 v149, 63, v0
    global_load_lds_dwordx4 v150, s[16:17]
    s_add_u32 m0, s67, 36096
    v_lshlrev_b32 v149, 2, v149
    global_load_lds_dwordx4 v151, s[16:17]
    global_load_ushort v141, v153, s[26:27]
    global_load_ushort v142, v153, s[26:27] offset:512
    global_load_ushort v139, v153, s[44:45]
    global_load_ushort v140, v153, s[44:45] offset:512
    global_load_ushort v132, v154, s[30:31]
    global_load_ushort v133, v154, s[32:33]
    global_load_ushort v134, v154, s[34:35]
    global_load_ushort v135, v154, s[36:37]
    global_load_ushort v136, v154, s[38:39]
    global_load_ushort v137, v154, s[40:41]
    global_load_ushort v138, v155, s[42:43]
    s_waitcnt vmcnt(15)
    v_cmp_eq_u32 vcc, 0, v0
    s_nop 0
    s_and_saveexec_b64 s[62:63], vcc
    v_mov_b32 v192, 0
    v_mov_b32 v193, 0
    v_mov_b32 v198, 0
    v_mov_b32 v199, 0
    s_mov_b64 exec, s[62:63]
    s_call_b64 s[60:61], L_expand
    s_call_b64 s[60:61], L_kfrag
    s_cmp_lg_u32 s5, 0
    s_cbranch_scc1 L_nodbg_1
    buffer_load_dword v148, v149, s[52:55], 0 offen sc1
L_nodbg_1:
    v_mul_u32_u24 v12, 48, v0
    v_add_u32 v12, 122688, v12
    ds_write_b128 v12, v[164:167] offset:0
    ds_write_b128 v12, v[168:171] offset:16
    ds_write_b128 v12, v[172:175] offset:32
    s_waitcnt vmcnt(0)
    s_cmp_lg_u32 s5, 0
    s_cbranch_scc1 L_nodbg2_2
L_d1_chk_3:
    v_cmp_gt_u32 vcc, 4, v148
    s_nop 0
    s_cbranch_vccnz L_d1_rt_4
L_d1_ok_5:
L_nodbg2_2:
    s_add_u32 s74, s80, 0
    s_add_u32 s75, s81, 2097152
    s_barrier
    buffer_load_dwordx4 v[144:147], v2, s[12:15], s74 offen sc1
    buffer_load_dwordx4 v[120:123], v3, s[12:15], s74 offen sc1
    v_subrev_u32 v131, 90944, v131
    ds_read_b64_tr_b16 v[64:65], v131 offset:0
    ds_read_b64_tr_b16 v[66:67], v131 offset:4352
    ds_read_b64_tr_b16 v[68:69], v131 offset:512
    ds_read_b64_tr_b16 v[70:71], v131 offset:4864
    s_mov_b32 s57, 0x05040100
    s_mov_b32 s58, 0x07060302
    v_lshlrev_b32 v128, 16, v141
    v_lshlrev_b32 v129, 16, v142
    s_waitcnt lgkmcnt(0)
    s_nop 0
    v_perm_b32 v80, v68, v64, s57
    v_perm_b32 v81, v68, v64, s58
    v_perm_b32 v82, v69, v65, s57
    v_perm_b32 v83, v69, v65, s58
    v_perm_b32 v84, v70, v66, s57
    v_perm_b32 v85, v70, v66, s58
    v_perm_b32 v86, v71, v67, s57
    v_perm_b32 v87, v71, v67, s58
    v_pk_mul_f32 v[64:65], v[104:105], v[128:129]
    v_pk_mul_f32 v[66:67], v[106:107], v[128:129]
    v_pk_mul_f32 v[68:69], v[108:109], v[128:129]
    v_pk_mul_f32 v[70:71], v[110:111], v[128:129]
    v_pk_mul_f32 v[72:73], v[112:113], v[128:129]
    v_pk_mul_f32 v[74:75], v[114:115], v[128:129]
    v_pk_mul_f32 v[76:77], v[116:117], v[128:129]
    v_pk_mul_f32 v[78:79], v[118:119], v[128:129]
    v_lshlrev_b32 v128, 16, v139
    v_lshlrev_b32 v129, 16, v140
    v_dot2_f32_bf16 v88, v80, s66, 0
    v_dot2_f32_bf16 v89, v81, s66, 0
    v_dot2_f32_bf16 v90, v82, s66, 0
    v_dot2_f32_bf16 v91, v83, s66, 0
    v_dot2_f32_bf16 v92, v84, s66, 0
    v_dot2_f32_bf16 v93, v85, s66, 0
    v_dot2_f32_bf16 v94, v86, s66, 0
    v_dot2_f32_bf16 v95, v87, s66, 0
    v_dot2_f32_bf16 v96, v80, v80, 0
    v_dot2_f32_bf16 v97, v81, v81, 0
    v_dot2_f32_bf16 v98, v82, v82, 0
    v_dot2_f32_bf16 v99, v83, v83, 0
    v_dot2_f32_bf16 v100, v84, v84, 0
    v_dot2_f32_bf16 v101, v85, v85, 0
    v_dot2_f32_bf16 v102, v86, v86, 0
    v_dot2_f32_bf16 v103, v87, v87, 0
    v_add_f32_dpp v88, v88, v88 row_shl:8 row_mask:0xf bank_mask:0x3
    v_add_f32_dpp v89, v89, v89 row_shl:8 row_mask:0xf bank_mask:0x3
    v_add_f32_dpp v90, v90, v90 row_shl:8 row_mask:0xf bank_mask:0x3
    v_add_f32_dpp v91, v91, v91 row_shl:8 row_mask:0xf bank_mask:0x3
    v_add_f32_dpp v92, v92, v92 row_shl:8 row_mask:0xf bank_mask:0x3
    v_add_f32_dpp v93, v93, v93 row_shl:8 row_mask:0xf bank_mask:0x3
    v_add_f32_dpp v94, v94, v94 row_shl:8 row_mask:0xf bank_mask:0x3
    v_add_f32_dpp v95, v95, v95 row_shl:8 row_mask:0xf bank_mask:0x3
    v_add_f32_dpp v88, v96, v96 row_shr:8 row_mask:0xf bank_mask:0xc
    v_add_f32_dpp v89, v97, v97 row_shr:8 row_mask:0xf bank_mask:0xc
    v_add_f32_dpp v90, v98, v98 row_shr:8 row_mask:0xf bank_mask:0xc
    v_add_f32_dpp v91, v99, v99 row_shr:8 row_mask:0xf bank_mask:0xc
    v_add_f32_dpp v92, v100, v100 row_shr:8 row_mask:0xf bank_mask:0xc
    v_add_f32_dpp v93, v101, v101 row_shr:8 row_mask:0xf bank_mask:0xc
    v_add_f32_dpp v94, v102, v102 row_shr:8 row_mask:0xf bank_mask:0xc
    v_add_f32_dpp v95, v103, v103 row_shr:8 row_mask:0xf bank_mask:0xc
    v_add_f32_dpp v88, v88, v88 row_shl:4 row_mask:0xf bank_mask:0x5
    v_add_f32_dpp v89, v89, v89 row_shl:4 row_mask:0xf bank_mask:0x5
    v_add_f32_dpp v90, v90, v90 row_shl:4 row_mask:0xf bank_mask:0x5
    v_add_f32_dpp v91, v91, v91 row_shl:4 row_mask:0xf bank_mask:0x5
    v_add_f32_dpp v88, v92, v92 row_shr:4 row_mask:0xf bank_mask:0xa
    v_add_f32_dpp v89, v93, v93 row_shr:4 row_mask:0xf bank_mask:0xa
    v_add_f32_dpp v90, v94, v94 row_shr:4 row_mask:0xf bank_mask:0xa
    v_add_f32_dpp v91, v95, v95 row_shr:4 row_mask:0xf bank_mask:0xa
    v_lshlrev_b32 v16, 16, v80
    v_permlane16_swap_b32 v88, v90
    v_permlane16_swap_b32 v89, v91
    v_add_f32 v88, v88, v90
    v_add_f32 v89, v89, v91
    v_and_b32 v17, 0xffff0000, v80
    v_lshlrev_b32 v18, 16, v81
    v_permlane32_swap_b32 v88, v89
    v_add_f32 v88, v88, v89
    v_and_b32 v19, 0xffff0000, v81
    v_lshlrev_b32 v20, 16, v82
    v_add_f32_dpp v88, v88, v88 quad_perm:[1,0,3,2] row_mask:0xf bank_mask:0xf
    v_and_b32 v21, 0xffff0000, v82
    v_lshlrev_b32 v22, 16, v83
    v_add_f32_dpp v88, v88, v88 quad_perm:[2,3,0,1] row_mask:0xf bank_mask:0xf
    ds_write_b32 v9, v88
    v_and_b32 v23, 0xffff0000, v83
    v_lshlrev_b32 v24, 16, v84
    v_and_b32 v25, 0xffff0000, v84
    v_lshlrev_b32 v26, 16, v85
    v_and_b32 v27, 0xffff0000, v85
    v_lshlrev_b32 v28, 16, v86
    v_and_b32 v29, 0xffff0000, v86
    v_lshlrev_b32 v30, 16, v87
    v_and_b32 v31, 0xffff0000, v87
    s_waitcnt lgkmcnt(0)
    s_barrier
    ds_read_b128 v[88:91], v10
    ds_read_b128 v[92:95], v10 offset:16
    v_xor_b32 v9, 256, v9
    v_xor_b32 v10, 256, v10
    s_waitcnt lgkmcnt(1)
    v_add_f32 v88, v88, v89
    v_add_f32 v90, v90, v91
    s_waitcnt lgkmcnt(0)
    v_add_f32 v92, v92, v93
    v_add_f32 v94, v94, v95
    v_add_f32 v88, v88, v90
    v_add_f32 v92, v92, v94
    v_mul_f32 v88, s83, v88
    v_mul_f32 v92, s83, v92
    v_fma_f32 v92, -v88, v88, v92
    v_max_f32 v92, 0, v92
    v_add_f32 v92, 0x3727c5ac, v92
    v_rsq_f32 v13, v92
    s_nop 0
    s_nop 0
    v_mul_f32_e64 v12, -v88, v13
    v_readlane_b32 s16, v13, 0
    v_readlane_b32 s17, v12, 0
    v_readlane_b32 s18, v13, 1
    v_readlane_b32 s19, v12, 1
    v_readlane_b32 s20, v13, 2
    v_readlane_b32 s21, v12, 2
    v_readlane_b32 s22, v13, 3
    v_readlane_b32 s23, v12, 3
    v_readlane_b32 s24, v13, 4
    v_readlane_b32 s25, v12, 4
    v_readlane_b32 s26, v13, 5
    v_readlane_b32 s27, v12, 5
    v_readlane_b32 s28, v13, 6
    v_readlane_b32 s29, v12, 6
    v_readlane_b32 s30, v13, 7
    v_readlane_b32 s31, v12, 7
    v_pk_fma_f32 v[48:49], v[16:17], s[16:17], s[16:17] op_sel:[0,0,1] op_sel_hi:[1,0,1]
    v_pk_fma_f32 v[50:51], v[18:19], s[18:19], s[18:19] op_sel:[0,0,1] op_sel_hi:[1,0,1]
    v_pk_fma_f32 v[52:53], v[20:21], s[20:21], s[20:21] op_sel:[0,0,1] op_sel_hi:[1,0,1]
    v_pk_fma_f32 v[54:55], v[22:23], s[22:23], s[22:23] op_sel:[0,0,1] op_sel_hi:[1,0,1]
    v_pk_fma_f32 v[56:57], v[24:25], s[24:25], s[24:25] op_sel:[0,0,1] op_sel_hi:[1,0,1]
    v_pk_fma_f32 v[58:59], v[26:27], s[26:27], s[26:27] op_sel:[0,0,1] op_sel_hi:[1,0,1]
    v_pk_fma_f32 v[60:61], v[28:29], s[28:29], s[28:29] op_sel:[0,0,1] op_sel_hi:[1,0,1]
    v_pk_fma_f32 v[62:63], v[30:31], s[30:31], s[30:31] op_sel:[0,0,1] op_sel_hi:[1,0,1]
    s_mov_b32 s84, 0
    s_add_u32 s72, s78, 2097152
    s_cmp_eq_u32 s6, 0
    s_cselect_b64 s[92:93], -1, 0
    s_cselect_b64 s[90:91], 0, -1
    s_waitcnt vmcnt(0)
L_c_chk_6:
    v_max3_u32 v12, v144, v145, v146
    v_max3_u32 v12, v12, v147, v120
    v_max3_u32 v12, v12, v121, v122
    v_max_u32 v12, v12, v123
    v_cmp_eq_u32 vcc, -1, v12
    s_nop 0
    s_cbranch_vccnz L_c_rt_7
L_c_ok_8:
    ds_write2st64_b32 v4, v144, v145 offset0:0 offset1:5
    ds_write2st64_b32 v4, v146, v147 offset0:10 offset1:15
    ds_write2st64_b32 v130, v144, v145 offset0:0 offset1:5
    ds_write2st64_b32 v130, v146, v147 offset0:10 offset1:15
    v_mov_b32 v12, -1
    v_mov_b32 v13, -1
    v_mov_b32 v14, -1
    v_mov_b32_e64 v15, -1
    ds_write2st64_b32 v4, v120, v121 offset0:2 offset1:7
    ds_write2st64_b32 v4, v122, v123 offset0:12 offset1:17
    ds_write2st64_b32 v130, v120, v121 offset0:2 offset1:7
    ds_write2st64_b32 v130, v122, v123 offset0:12 offset1:17
    s_cmp_lg_u32 s77, 0
    s_waitcnt lgkmcnt(0)
    s_barrier
    s_cbranch_scc1 L_p1A_1
L_p1A_0:
    ds_read_b128 v[164:167], v5 offset:0
    ds_read_b128 v[168:171], v5 offset:1280
    ds_read_b128 v[172:175], v5 offset:2560
    ds_read_b128 v[176:179], v5 offset:3840
    ds_read_b128 v[180:183], v5 offset:64
    ds_read_b128 v[184:187], v5 offset:1344
    s_waitcnt lgkmcnt(5)
    v_mfma_f32_16x16x32_bf16 v[152:155], a[28:31], v[164:167], 0
    ds_read_b128 v[188:191], v5 offset:2624
    v_lshlrev_b32 v208, 16, v132
    v_lshlrev_b32 v209, 16, v133
    v_lshlrev_b32 v210, 16, v134
    v_mfma_f32_16x16x32_bf16 v[148:151], a[4:7], v[164:167], 0
    s_add_u32 s82, s79, 4194304
    buffer_store_dwordx4 v[12:15], v1, s[12:15], s82 offen sc1
    v_lshlrev_b32 v211, 16, v135
    v_lshlrev_b32 v212, 16, v136
    v_lshlrev_b32 v213, 16, v137
    s_waitcnt lgkmcnt(5)
    v_mfma_f32_16x16x32_bf16 v[152:155], a[92:95], v[168:171], v[152:155]
    ds_read_b128 v[192:195], v5 offset:3904
    v_lshlrev_b32 v214, 16, v138
    s_lshr_b32 s57, s5, 1
    s_mul_i32 s57, s57, 28832
    v_mfma_f32_16x16x32_bf16 v[148:151], a[68:71], v[168:171], v[148:151]
    s_lshl_b32 s58, s77, 8
    s_add_u32 s57, s57, s58
    s_waitcnt lgkmcnt(4)
    v_mfma_f32_16x16x32_bf16 v[152:155], a[156:159], v[172:175], v[152:155]
    ds_read_b128 v[196:199], v5 offset:128
    s_add_u32 s82, s79, 4194304
    buffer_store_dwordx4 v[12:15], v11, s[12:15], s82 offen sc1
    s_add_u32 m0, s57, 31744
    s_mov_b32 s57, 0x3fb8aa3b
    v_mfma_f32_16x16x32_bf16 v[148:151], a[132:135], v[172:175], v[148:151]
    s_mov_b32 s58, 0x32a57060
    v_mul_f32 v215, s57, v214
    v_fma_f32 v216, v214, s57, -v215
    v_exp_f32 v215, v215
    v_mfma_f32_16x16x32_bf16 v[152:155], a[220:223], v[176:179], v[152:155]
    ds_read_b128 v[164:167], v5 offset:1408
    v_fma_f32 v216, v214, s58, v216
    v_mul_f32 v216, 0x3f317218, v216
    v_fma_f32 v215, v215, v216, v215
    v_mfma_f32_16x16x32_bf16 v[148:151], a[196:199], v[176:179], v[148:151]
    v_cvt_pk_bf16_f32 v215, v215, v215
    v_and_b32 v215, 0xffff0000, v215
    s_waitcnt lgkmcnt(4)
    v_mfma_f32_16x16x32_bf16 v[152:155], a[24:27], v[180:183], v[152:155]
    ds_read_b128 v[168:171], v5 offset:2688
    v_mov_b32 v255, 0x3f80
    v_mul_f32 v208, v215, v208
    v_mul_f32 v209, v215, v209
    v_mfma_f32_16x16x32_bf16 v[148:151], a[0:3], v[180:183], v[148:151]
    v_mul_f32 v210, v215, v210
    v_mul_f32 v211, v215, v211
    v_mul_f32 v208, s57, v208
    v_mfma_f32_16x16x32_bf16 v[152:155], a[88:91], v[184:187], v[152:155]
    ds_read_b128 v[172:175], v5 offset:3968
    v_mul_f32 v209, 0.15915494, v209
    v_mul_f32 v216, v212, v210
    v_mul_f32 v217, v212, v211
    v_mfma_f32_16x16x32_bf16 v[148:151], a[64:67], v[184:187], v[148:151]
    v_fma_f32 v216, -v213, v211, v216
    v_fmac_f32 v217, v213, v210
    s_waitcnt lgkmcnt(4)
    v_mfma_f32_16x16x32_bf16 v[152:155], a[152:155], v[188:191], v[152:155]
    ds_read_b128 v[176:179], v5 offset:192
    ds_write_addtid_b32 v255
    v_mul_f32 v218, 1.0, v208
    v_mul_f32 v219, 1.0, v209
    v_mfma_f32_16x16x32_bf16 v[148:151], a[128:131], v[188:191], v[148:151]
    v_mul_f32 v220, 0x41000000, v208
    v_mul_f32 v221, 0x41000000, v209
    v_mul_f32 v222, 0x43000000, v208
    v_mfma_f32_16x16x32_bf16 v[152:155], a[216:219], v[192:195], v[152:155]
    ds_read_b128 v[180:183], v5 offset:1472
    v_mul_f32 v223, 0x43000000, v209
    v_mul_f32 v224, 0x43800000, v208
    v_mfma_f32_16x16x32_bf16 v[148:151], a[192:195], v[192:195], v[148:151]
    v_mul_f32 v225, 0x43800000, v209
    v_fract_f32 v219, v219
    v_exp_f32 v218, v218
    s_waitcnt lgkmcnt(5)
    v_mfma_f32_16x16x32_bf16 v[152:155], a[20:23], v[196:199], v[152:155]
    ds_read_b128 v[184:187], v5 offset:2752
    v_fract_f32 v221, v221
    v_exp_f32 v220, v220
    v_fract_f32 v223, v223
    v_mfma_f32_16x16x32_bf16 v[152:155], a[84:87], v[164:167], v[152:155]
    ds_read_b128 v[188:191], v5 offset:4032
    v_exp_f32 v222, v222
    v_fract_f32 v225, v225
    v_exp_f32 v224, v224
    s_waitcnt lgkmcnt(5)
    v_mfma_f32_16x16x32_bf16 v[152:155], a[148:151], v[168:171], v[152:155]
    ds_read_b128 v[192:195], v5 offset:256
    v_cos_f32 v208, v219
    v_sin_f32 v219, v219
    v_mfma_f32_16x16x32_bf16 v[152:155], a[212:215], v[172:175], v[152:155]
    ds_read_b128 v[196:199], v5 offset:1536
    v_cos_f32 v209, v221
    v_sin_f32 v221, v221
    v_cos_f32 v210, v223
    s_waitcnt lgkmcnt(4)
    v_mfma_f32_16x16x32_bf16 v[152:155], a[16:19], v[176:179], v[152:155]
    ds_read_b128 v[164:167], v5 offset:2816
    v_sin_f32 v223, v223
    v_cos_f32 v211, v225
    v_sin_f32 v225, v225
    v_mfma_f32_16x16x32_bf16 v[152:155], a[80:83], v[180:183], v[152:155]
    ds_read_b128 v[168:171], v5 offset:4096
    v_mul_f32 v219, v218, v219
    v_mul_f32 v218, v218, v208
    v_mul_f32 v221, v220, v221
    s_waitcnt lgkmcnt(4)
    v_mfma_f32_16x16x32_bf16 v[152:155], a[144:147], v[184:187], v[152:155]
    ds_read_b128 v[172:175], v5 offset:320
    v_mul_f32 v220, v220, v209
    v_mul_f32 v223, v222, v223
    v_mfma_f32_16x16x32_bf16 v[152:155], a[208:211], v[188:191], v[152:155]
    ds_read_b128 v[176:179], v5 offset:1600
    v_mul_f32 v222, v222, v210
    v_mul_f32 v225, v224, v225
    v_mul_f32 v224, v224, v211
    s_waitcnt lgkmcnt(4)
    v_mfma_f32_16x16x32_bf16 v[152:155], a[12:15], v[192:195], v[152:155]
    ds_read_b128 v[180:183], v5 offset:2880
    v_sub_f32 v252, 0, v221
    v_sub_f32 v253, 0, v219
    v_sub_f32 v254, 0, v225
    v_mfma_f32_16x16x32_bf16 v[152:155], a[76:79], v[196:199], v[152:155]
    ds_read_b128 v[184:187], v5 offset:4160
    v_mul_f32 v226, v218, v218
    v_mul_f32 v227, v218, v219
    v_cvt_pk_bf16_f32 v208, v220, v221
    s_waitcnt lgkmcnt(4)
    v_mfma_f32_16x16x32_bf16 v[152:155], a[140:143], v[164:167], v[152:155]
    ds_read_b128 v[188:191], v5 offset:384
    v_fmac_f32 v226, v219, v253
    v_mfma_f32_16x16x32_bf16 v[152:155], a[204:207], v[168:171], v[152:155]
    ds_read_b128 v[192:195], v5 offset:1664
    ds_write_addtid_b32 v208 offset:544
    v_fmac_f32 v227, v219, v218
    v_mul_f32 v228, v226, v226
    v_mul_f32 v229, v226, v227
    s_waitcnt lgkmcnt(5)
    v_mfma_f32_16x16x32_bf16 v[152:155], a[8:11], v[172:175], v[152:155]
    ds_read_b128 v[196:199], v5 offset:2944
    v_cvt_pk_bf16_f32 v209, v222, v223
    v_fma_f32 v228, -v227, v227, v228
    v_mfma_f32_16x16x32_bf16 v[152:155], a[72:75], v[176:179], v[152:155]
    ds_read_b128 v[164:167], v5 offset:4224
    ds_write_addtid_b32 v209 offset:8704
    v_fmac_f32 v229, v227, v226
    v_cvt_pk_bf16_f32 v210, v216, -v217
    s_waitcnt lgkmcnt(6)
    v_mfma_f32_16x16x32_bf16 v[152:155], a[136:139], v[180:183], v[152:155]
    ds_read_b128 v[168:171], v5 offset:448
    v_mul_f32 v230, v220, v220
    v_mul_f32 v231, v220, v221
    v_mfma_f32_16x16x32_bf16 v[152:155], a[200:203], v[184:187], v[152:155]
    ds_read_b128 v[172:175], v5 offset:1728
    ds_write_addtid_b32 v210 offset:17408
    v_mul_f32 v234, v222, v220
    v_mul_f32 v235, v222, v221
    v_mul_f32 v238, v216, v218
    s_waitcnt lgkmcnt(7)
    v_mfma_f32_16x16x32_bf16 v[152:155], a[4:7], v[188:191], v[152:155]
    ds_read_b128 v[176:179], v5 offset:3008
    v_mul_f32 v239, v216, v219
    v_mul_f32 v242, v216, v224
    v_mul_f32 v243, v216, v225
    v_mfma_f32_16x16x32_bf16 v[152:155], a[68:71], v[192:195], v[152:155]
    ds_read_b128 v[180:183], v5 offset:4288
    v_fmac_f32 v230, v221, v252
    v_fmac_f32 v231, v221, v220
    s_waitcnt lgkmcnt(6)
    v_mfma_f32_16x16x32_bf16 v[152:155], a[132:135], v[196:199], v[152:155]
    ds_read_b128 v[184:187], v5 offset:448
    v_cvt_pk_bf16_f32 v156, v148, v149
    v_fmac_f32 v234, v223, v252
    v_fmac_f32 v235, v223, v220
    v_fmac_f32 v238, v217, v253
    v_mfma_f32_16x16x32_bf16 v[152:155], a[196:199], v[164:167], v[152:155]
    ds_read_b128 v[188:191], v5 offset:1728
    v_cvt_pk_bf16_f32 v157, v150, v151
    v_fmac_f32 v239, v217, v218
    v_fmac_f32 v242, v217, v254
    v_fmac_f32 v243, v217, v224
    s_waitcnt lgkmcnt(5)
    v_mfma_f32_16x16x32_bf16 v[152:155], a[0:3], v[168:171], v[152:155]
    ds_read_b128 v[192:195], v5 offset:3008
    ds_write_b64 v7, v[156:157] offset:0
    v_cvt_pk_bf16_f32 v211, v230, v231
    v_cvt_pk_bf16_f32 v212, v234, v235
    v_mfma_f32_16x16x32_bf16 v[152:155], a[64:67], v[172:175], v[152:155]
    ds_read_b128 v[196:199], v5 offset:4288
    ds_write_addtid_b32 v211 offset:1088
    v_cvt_pk_bf16_f32 v213, v238, -v239
    s_waitcnt lgkmcnt(6)
    v_mfma_f32_16x16x32_bf16 v[152:155], a[128:131], v[176:179], v[152:155]
    ds_read_b128 v[164:167], v5 offset:384
    ds_write_addtid_b32 v212 offset:9248
    v_cvt_pk_bf16_f32 v214, v242, -v243
    v_mul_f32 v232, v230, v220
    v_mfma_f32_16x16x32_bf16 v[152:155], a[192:195], v[180:183], v[152:155]
    ds_read_b128 v[168:171], v5 offset:1664
    ds_write_addtid_b32 v213 offset:17952
    v_mul_f32 v233, v230, v221
    v_mul_f32 v236, v234, v220
    s_waitcnt lgkmcnt(8)
    v_mfma_f32_16x16x32_bf16 v[200:203], a[8:11], v[184:187], 0
    ds_read_b128 v[172:175], v5 offset:2944
    ds_read_b64_tr_b16 a[40:41], v6 offset:2592
    ds_write_addtid_b32 v214 offset:21760
    v_mul_f32 v237, v234, v221
    v_mul_f32 v240, v238, v218
    v_mfma_f32_16x16x32_bf16 v[204:207], a[32:35], v[184:187], 0
    ds_read_b64_tr_b16 a[42:43], v6 offset:2560
    v_mul_f32 v241, v238, v219
    v_mul_f32 v244, v242, v224
    v_mul_f32 v245, v242, v225
    v_mfma_f32_16x16x32_bf16 v[200:203], a[72:75], v[188:191], v[200:203]
    ds_read_b128 v[176:179], v5 offset:4224
    ds_read_b64_tr_b16 a[104:105], v6 offset:6752
    v_cvt_pk_bf16_f32 v158, v152, v153
    v_fmac_f32 v232, v231, v252
    v_fmac_f32 v233, v231, v220
    v_mfma_f32_16x16x32_bf16 v[204:207], a[96:99], v[188:191], v[204:207]
    ds_read_b64_tr_b16 a[106:107], v6 offset:6720
    v_cvt_pk_bf16_f32 v159, v154, v155
    v_fmac_f32 v236, v235, v252
    v_fmac_f32 v237, v235, v220
    v_fmac_f32 v240, v239, v253
    s_waitcnt lgkmcnt(12)
    v_mfma_f32_16x16x32_bf16 v[200:203], a[136:139], v[192:195], v[200:203]
    ds_read_b128 v[180:183], v5 offset:320
    ds_read_b64_tr_b16 a[168:169], v6 offset:10912
    ds_write_b64 v7, v[158:159] offset:3840
    v_fmac_f32 v241, v239, v218
    v_fmac_f32 v244, v243, v254
    v_mfma_f32_16x16x32_bf16 v[204:207], a[160:163], v[192:195], v[204:207]
    ds_read_b64_tr_b16 a[170:171], v6 offset:10880
    v_fmac_f32 v245, v243, v224
    v_cvt_pk_bf16_f32 v215, v232, v233
    v_cvt_pk_bf16_f32 v208, v236, v237
    v_mfma_f32_16x16x32_bf16 v[200:203], a[200:203], v[196:199], v[200:203]
    ds_read_b128 v[184:187], v5 offset:1600
    ds_read_b64_tr_b16 a[232:233], v6 offset:15072
    ds_write_addtid_b32 v215 offset:1632
    v_cvt_pk_bf16_f32 v209, v240, -v241
    v_cvt_pk_bf16_f32 v210, v244, -v245
    v_mfma_f32_16x16x32_bf16 v[204:207], a[224:227], v[196:199], v[204:207]
    ds_read_b64_tr_b16 a[234:235], v6 offset:15040
    ds_write_addtid_b32 v208 offset:9792
    v_mul_f32 v230, v232, v220
    s_waitcnt lgkmcnt(15)
    v_mfma_f32_16x16x32_bf16 v[200:203], a[12:15], v[164:167], v[200:203]
    ds_read_b128 v[188:191], v5 offset:2880
    ds_read_b64_tr_b16 a[44:45], v6 offset:2848
    ds_write_addtid_b32 v209 offset:18496
    ds_write_addtid_b32 v210 offset:23936
    s_waitcnt vmcnt(0)
    s_waitcnt lgkmcnt(10)
    s_barrier
    v_mfma_f32_16x16x32_bf16 v[204:207], a[36:39], v[164:167], v[204:207]
    ds_read_b64_tr_b16 a[46:47], v6 offset:2816
    ds_read_b128 v[160:163], v8
    v_mul_f32 v231, v232, v221
    v_mul_f32 v234, v236, v220
    v_mul_f32 v235, v236, v221
    v_mfma_f32_16x16x32_bf16 v[200:203], a[76:79], v[168:171], v[200:203]
    ds_read_b128 v[192:195], v5 offset:4160
    ds_read_b64_tr_b16 a[108:109], v6 offset:7008
    v_mul_f32 v238, v240, v218
    v_mul_f32 v239, v240, v219
    v_mul_f32 v246, v244, v224
    v_mfma_f32_16x16x32_bf16 v[204:207], a[100:103], v[168:171], v[204:207]
    ds_read_b64_tr_b16 a[110:111], v6 offset:6976
    v_mul_f32 v247, v244, v225
    v_fmac_f32 v230, v233, v252
    v_fmac_f32 v231, v233, v220
    v_fmac_f32 v234, v237, v252
    v_mfma_f32_16x16x32_bf16 v[200:203], a[140:143], v[172:175], v[200:203]
    ds_read_b128 v[196:199], v5 offset:256
    ds_read_b64_tr_b16 a[172:173], v6 offset:11168
    v_fmac_f32 v235, v237, v220
    v_fmac_f32 v238, v241, v253
    v_fmac_f32 v239, v241, v218
    v_mfma_f32_16x16x32_bf16 v[204:207], a[164:167], v[172:175], v[204:207]
    ds_read_b64_tr_b16 a[174:175], v6 offset:11136
    s_waitcnt lgkmcnt(6)
    buffer_store_dwordx4 v[160:163], v1, s[12:15], s75 offen sc1
    v_fmac_f32 v246, v245, v254
    v_fmac_f32 v247, v245, v224
    v_mfma_f32_16x16x32_bf16 v[200:203], a[204:207], v[176:179], v[200:203]
    ds_read_b128 v[164:167], v5 offset:1536
    ds_read_b64_tr_b16 a[236:237], v6 offset:15328
    v_cvt_pk_bf16_f32 v211, v230, v231
    v_cvt_pk_bf16_f32 v212, v234, v235
    v_cvt_pk_bf16_f32 v213, v238, -v239
    v_mfma_f32_16x16x32_bf16 v[204:207], a[228:231], v[176:179], v[204:207]
    ds_read_b64_tr_b16 a[238:239], v6 offset:15296
    ds_write_addtid_b32 v211 offset:2176
    v_cvt_pk_bf16_f32 v214, v246, -v247
    v_mfma_f32_16x16x32_bf16 v[200:203], a[16:19], v[180:183], v[200:203]
    ds_read_b128 v[168:171], v5 offset:2816
    ds_read_b64_tr_b16 a[48:49], v6 offset:3104
    ds_write_addtid_b32 v212 offset:10336
    v_mul_f32 v232, v230, v220
    v_mfma_f32_16x16x32_bf16 v[204:207], a[40:43], v[180:183], v[204:207]
    ds_read_b64_tr_b16 a[50:51], v6 offset:3072
    ds_write_addtid_b32 v213 offset:19040
    ds_write_addtid_b32 v214 offset:25024
    s_add_u32 s82, s81, 6291456
    buffer_store_dwordx4 v[12:15], v1, s[12:15], s82 offen sc1
    v_mfma_f32_16x16x32_bf16 v[200:203], a[80:83], v[184:187], v[200:203]
    ds_read_b128 v[172:175], v5 offset:4096
    ds_read_b64_tr_b16 a[112:113], v6 offset:7264
    v_mul_f32 v233, v230, v221
    v_mul_f32 v236, v234, v220
    v_mul_f32 v237, v234, v221
    v_mfma_f32_16x16x32_bf16 v[204:207], a[104:107], v[184:187], v[204:207]
    ds_read_b64_tr_b16 a[114:115], v6 offset:7232
    v_mul_f32 v240, v238, v218
    v_mul_f32 v241, v238, v219
    v_mul_f32 v248, v246, v224
    v_mul_f32 v249, v246, v225
    s_waitcnt lgkmcnt(15)
    v_mfma_f32_16x16x32_bf16 v[200:203], a[144:147], v[188:191], v[200:203]
    ds_read_b128 v[176:179], v5 offset:192
    ds_read_b64_tr_b16 a[176:177], v6 offset:11424
    v_fmac_f32 v232, v231, v252
    v_fmac_f32 v233, v231, v220
    v_fmac_f32 v236, v235, v252
    v_mfma_f32_16x16x32_bf16 v[204:207], a[168:171], v[188:191], v[204:207]
    ds_read_b64_tr_b16 a[178:179], v6 offset:11392
    v_fmac_f32 v237, v235, v220
    v_fmac_f32 v240, v239, v253
    v_fmac_f32 v241, v239, v218
    v_fmac_f32 v248, v247, v254
    v_mfma_f32_16x16x32_bf16 v[200:203], a[208:211], v[192:195], v[200:203]
    ds_read_b128 v[180:183], v5 offset:1472
    ds_read_b64_tr_b16 a[240:241], v6 offset:15584
    v_fmac_f32 v249, v247, v224
    v_cvt_pk_bf16_f32 v215, v232, v233
    v_cvt_pk_bf16_f32 v208, v236, v237
    v_mfma_f32_16x16x32_bf16 v[204:207], a[232:235], v[192:195], v[204:207]
    ds_read_b64_tr_b16 a[242:243], v6 offset:15552
    v_cvt_pk_bf16_f32 v209, v240, -v241
    s_waitcnt lgkmcnt(15)
    v_mfma_f32_16x16x32_bf16 v[200:203], a[20:23], v[196:199], v[200:203]
    ds_read_b128 v[184:187], v5 offset:2752
    ds_read_b64_tr_b16 a[52:53], v6 offset:3360
    ds_write_addtid_b32 v215 offset:2720
    v_cvt_pk_bf16_f32 v210, v248, -v249
    v_mfma_f32_16x16x32_bf16 v[204:207], a[44:47], v[196:199], v[204:207]
    ds_read_b64_tr_b16 a[54:55], v6 offset:3328
    ds_write_addtid_b32 v208 offset:10880
    ds_write_addtid_b32 v209 offset:19584
    v_mul_f32 v230, v232, v220
    v_mul_f32 v231, v232, v221
    v_mfma_f32_16x16x32_bf16 v[200:203], a[84:87], v[164:167], v[200:203]
    ds_read_b128 v[188:191], v5 offset:4032
    ds_read_b64_tr_b16 a[116:117], v6 offset:7520
    ds_write_addtid_b32 v210 offset:26112
    v_mul_f32 v234, v236, v220
    v_mul_f32 v235, v236, v221
    v_mfma_f32_16x16x32_bf16 v[204:207], a[108:111], v[164:167], v[204:207]
    ds_read_b64_tr_b16 a[118:119], v6 offset:7488
    s_add_u32 s82, s81, 6291456
    buffer_store_dwordx4 v[12:15], v11, s[12:15], s82 offen sc1
    v_mul_f32 v238, v240, v218
    v_mul_f32 v239, v240, v219
    s_waitcnt lgkmcnt(15)
    v_mfma_f32_16x16x32_bf16 v[200:203], a[148:151], v[168:171], v[200:203]
    ds_read_b128 v[192:195], v5 offset:128
    ds_read_b64_tr_b16 a[180:181], v6 offset:11680
    v_mul_f32 v250, v248, v224
    v_mul_f32 v251, v248, v225
    v_fmac_f32 v230, v233, v252
    v_mfma_f32_16x16x32_bf16 v[204:207], a[172:175], v[168:171], v[204:207]
    ds_read_b64_tr_b16 a[182:183], v6 offset:11648
    v_fmac_f32 v231, v233, v220
    v_fmac_f32 v234, v237, v252
    v_fmac_f32 v235, v237, v220
    v_fmac_f32 v238, v241, v253
    v_mfma_f32_16x16x32_bf16 v[200:203], a[212:215], v[172:175], v[200:203]
    ds_read_b128 v[196:199], v5 offset:1408
    ds_read_b64_tr_b16 a[244:245], v6 offset:15840
    v_fmac_f32 v239, v241, v218
    v_fmac_f32 v250, v249, v254
    v_mfma_f32_16x16x32_bf16 v[204:207], a[236:239], v[172:175], v[204:207]
    ds_read_b64_tr_b16 a[246:247], v6 offset:15808
    v_fmac_f32 v251, v249, v224
    v_cvt_pk_bf16_f32 v211, v230, v231
    v_cvt_pk_bf16_f32 v212, v234, v235
    s_waitcnt lgkmcnt(15)
    v_mfma_f32_16x16x32_bf16 v[200:203], a[24:27], v[176:179], v[200:203]
    ds_read_b128 v[164:167], v5 offset:2688
    ds_read_b64_tr_b16 a[56:57], v6 offset:3616
    v_cvt_pk_bf16_f32 v213, v238, -v239
    v_mfma_f32_16x16x32_bf16 v[204:207], a[48:51], v[176:179], v[204:207]
    ds_read_b64_tr_b16 a[58:59], v6 offset:3584
    ds_write_addtid_b32 v211 offset:3264
    ds_write_addtid_b32 v212 offset:11424
    v_cvt_pk_bf16_f32 v214, v250, -v251
    v_mul_f32 v232, v230, v220
    v_mfma_f32_16x16x32_bf16 v[200:203], a[88:91], v[180:183], v[200:203]
    ds_read_b128 v[168:171], v5 offset:3968
    ds_read_b64_tr_b16 a[120:121], v6 offset:7776
    ds_write_addtid_b32 v213 offset:20128
    v_mul_f32 v233, v230, v221
    v_mfma_f32_16x16x32_bf16 v[204:207], a[112:115], v[180:183], v[204:207]
    ds_read_b64_tr_b16 a[122:123], v6 offset:7744
    ds_write_addtid_b32 v214 offset:26656
    v_mul_f32 v236, v234, v220
    v_mul_f32 v237, v234, v221
    v_mul_f32 v240, v238, v218
    s_waitcnt lgkmcnt(15)
    v_mfma_f32_16x16x32_bf16 v[200:203], a[152:155], v[184:187], v[200:203]
    ds_read_b128 v[172:175], v5 offset:64
    ds_read_b64_tr_b16 a[184:185], v6 offset:11936
    v_mul_f32 v241, v238, v219
    v_mul_f32 v248, v250, v224
    v_mul_f32 v249, v250, v225
    v_mfma_f32_16x16x32_bf16 v[204:207], a[176:179], v[184:187], v[204:207]
    ds_read_b64_tr_b16 a[186:187], v6 offset:11904
    s_add_u32 s82, s81, 10485760
    buffer_store_dwordx4 v[12:15], v1, s[12:15], s82 offen sc1
    v_fmac_f32 v232, v231, v252
    v_fmac_f32 v233, v231, v220
    v_mfma_f32_16x16x32_bf16 v[200:203], a[216:219], v[188:191], v[200:203]
    ds_read_b128 v[176:179], v5 offset:1344
    ds_read_b64_tr_b16 a[248:249], v6 offset:16096
    v_fmac_f32 v236, v235, v252
    v_fmac_f32 v237, v235, v220
    v_fmac_f32 v240, v239, v253
    v_mfma_f32_16x16x32_bf16 v[204:207], a[240:243], v[188:191], v[204:207]
    ds_read_b64_tr_b16 a[250:251], v6 offset:16064
    v_fmac_f32 v241, v239, v218
    v_fmac_f32 v248, v251, v254
    v_fmac_f32 v249, v251, v224
    s_waitcnt lgkmcnt(15)
    v_mfma_f32_16x16x32_bf16 v[200:203], a[28:31], v[192:195], v[200:203]
    ds_read_b128 v[180:183], v5 offset:2624
    ds_read_b64_tr_b16 a[60:61], v6 offset:3872
    v_cvt_pk_bf16_f32 v215, v232, v233
    v_cvt_pk_bf16_f32 v208, v236, v237
    v_mfma_f32_16x16x32_bf16 v[204:207], a[52:55], v[192:195], v[204:207]
    ds_read_b64_tr_b16 a[62:63], v6 offset:3840
    ds_write_addtid_b32 v215 offset:3808
    v_cvt_pk_bf16_f32 v209, v240, -v241
    v_cvt_pk_bf16_f32 v210, v248, -v249
    v_mfma_f32_16x16x32_bf16 v[200:203], a[92:95], v[196:199], v[200:203]
    ds_read_b128 v[184:187], v5 offset:3904
    ds_read_b64_tr_b16 a[124:125], v6 offset:8032
    ds_write_addtid_b32 v208 offset:11968
    v_mul_f32 v230, v232, v220
    v_mfma_f32_16x16x32_bf16 v[204:207], a[116:119], v[196:199], v[204:207]
    ds_read_b64_tr_b16 a[126:127], v6 offset:8000
    ds_write_addtid_b32 v209 offset:20672
    v_mul_f32 v231, v232, v221
    v_mul_f32 v234, v236, v220
    s_waitcnt lgkmcnt(15)
    v_mfma_f32_16x16x32_bf16 v[200:203], a[156:159], v[164:167], v[200:203]
    ds_read_b128 v[188:191], v5 offset:0
    ds_read_b64_tr_b16 a[188:189], v6 offset:12192
    ds_write_addtid_b32 v210 offset:27200
    v_mul_f32 v235, v236, v221
    v_mul_f32 v238, v240, v218
    v_mfma_f32_16x16x32_bf16 v[204:207], a[180:183], v[164:167], v[204:207]
    ds_read_b64_tr_b16 a[190:191], v6 offset:12160
    v_mul_f32 v239, v240, v219
    v_mul_f32 v250, v248, v224
    v_mul_f32 v251, v248, v225
    v_mfma_f32_16x16x32_bf16 v[200:203], a[220:223], v[168:171], v[200:203]
    ds_read_b128 v[192:195], v5 offset:1280
    ds_read_b64_tr_b16 a[252:253], v6 offset:16352
    v_fmac_f32 v230, v233, v252
    v_fmac_f32 v231, v233, v220
    v_fmac_f32 v234, v237, v252
    v_mfma_f32_16x16x32_bf16 v[204:207], a[244:247], v[168:171], v[204:207]
    ds_read_b64_tr_b16 a[254:255], v6 offset:16320
    s_add_u32 s82, s81, 10485760
    buffer_store_dwordx4 v[12:15], v11, s[12:15], s82 offen sc1
    v_fmac_f32 v235, v237, v220
    v_fmac_f32 v238, v241, v253
    s_waitcnt lgkmcnt(15)
    v_mfma_f32_16x16x32_bf16 v[200:203], a[32:35], v[172:175], v[200:203]
    ds_read_b128 v[196:199], v5 offset:2560
    v_fmac_f32 v239, v241, v218
    v_fmac_f32 v250, v249, v254
    v_fmac_f32 v251, v249, v224
    v_cvt_pk_bf16_f32 v211, v230, v231
    v_mfma_f32_16x16x32_bf16 v[204:207], a[56:59], v[172:175], v[204:207]
    v_cvt_pk_bf16_f32 v212, v234, v235
    v_cvt_pk_bf16_f32 v213, v238, -v239
    v_mfma_f32_16x16x32_bf16 v[200:203], a[96:99], v[176:179], v[200:203]
    ds_read_b128 v[164:167], v5 offset:3840
    ds_write_addtid_b32 v211 offset:4352
    v_cvt_pk_bf16_f32 v214, v250, -v251
    v_mfma_f32_16x16x32_bf16 v[204:207], a[120:123], v[176:179], v[204:207]
    ds_write_addtid_b32 v212 offset:12512
    v_mul_f32 v232, v230, v220
    s_waitcnt lgkmcnt(15)
    v_mfma_f32_16x16x32_bf16 v[200:203], a[160:163], v[180:183], v[200:203]
    ds_read_b128 v[168:171], v5 offset:512
    ds_write_addtid_b32 v213 offset:21216
    ds_write_addtid_b32 v214 offset:27744
    v_mul_f32 v233, v230, v221
    v_mul_f32 v236, v234, v220
    v_mfma_f32_16x16x32_bf16 v[204:207], a[184:187], v[180:183], v[204:207]
    v_mul_f32 v237, v234, v221
    v_mul_f32 v248, v250, v224
    v_mul_f32 v249, v250, v225
    v_mfma_f32_16x16x32_bf16 v[200:203], a[224:227], v[184:187], v[200:203]
    ds_read_b128 v[172:175], v5 offset:1792
    v_fmac_f32 v232, v231, v252
    v_fmac_f32 v233, v231, v220
    v_fmac_f32 v236, v235, v252
    v_mfma_f32_16x16x32_bf16 v[204:207], a[248:251], v[184:187], v[204:207]
    v_fmac_f32 v237, v235, v220
    v_fmac_f32 v248, v251, v254
    v_fmac_f32 v249, v251, v224
    s_waitcnt lgkmcnt(10)
    v_mfma_f32_16x16x32_bf16 v[200:203], a[36:39], v[188:191], v[200:203]
    ds_read_b128 v[176:179], v5 offset:3072
    v_cvt_pk_bf16_f32 v215, v232, v233
    v_cvt_pk_bf16_f32 v208, v236, v237
    v_mfma_f32_16x16x32_bf16 v[204:207], a[60:63], v[188:191], v[204:207]
    v_cvt_pk_bf16_f32 v209, v248, -v249
    v_mul_f32 v230, v232, v220
    v_mfma_f32_16x16x32_bf16 v[200:203], a[100:103], v[192:195], v[200:203]
    ds_read_b128 v[180:183], v5 offset:4352
    ds_write_addtid_b32 v215 offset:4896
    ds_write_addtid_b32 v208 offset:13056
    v_mul_f32 v231, v232, v221
    v_mfma_f32_16x16x32_bf16 v[204:207], a[124:127], v[192:195], v[204:207]
    ds_write_addtid_b32 v209 offset:28288
    v_mul_f32 v234, v236, v220
    v_mul_f32 v235, v236, v221
    v_mul_f32 v238, v242, v226
    s_waitcnt lgkmcnt(11)
    v_mfma_f32_16x16x32_bf16 v[200:203], a[164:167], v[196:199], v[200:203]
    ds_read_b128 v[184:187], v5 offset:576
    v_mul_f32 v239, v242, v227
    v_fmac_f32 v230, v233, v252
    v_mfma_f32_16x16x32_bf16 v[204:207], a[188:191], v[196:199], v[204:207]
    v_fmac_f32 v231, v233, v220
    v_fmac_f32 v234, v237, v252
    v_fmac_f32 v235, v237, v220
    v_mfma_f32_16x16x32_bf16 v[200:203], a[228:231], v[164:167], v[200:203]
    ds_read_b128 v[188:191], v5 offset:1856
    v_fma_f32 v238, -v243, v227, v238
    v_fmac_f32 v239, v243, v226
    v_cvt_pk_bf16_f32 v210, v230, v231
    v_mfma_f32_16x16x32_bf16 v[204:207], a[252:255], v[164:167], v[204:207]
    v_cvt_pk_bf16_f32 v211, v234, v235
    v_cvt_pk_bf16_f32 v212, v238, -v239
    s_waitcnt lgkmcnt(7)
    v_mfma_f32_16x16x32_bf16 v[204:207], a[28:31], v[168:171], v[204:207]
    ds_read_b128 v[192:195], v5 offset:3136
    ds_write_addtid_b32 v210 offset:5440
    v_mul_f32 v232, v230, v220
    v_mfma_f32_16x16x32_bf16 v[200:203], a[4:7], v[168:171], v[200:203]
    ds_write_addtid_b32 v211 offset:13600
    v_mul_f32 v233, v230, v221
    v_mul_f32 v236, v234, v220
    v_mfma_f32_16x16x32_bf16 v[204:207], a[92:95], v[172:175], v[204:207]
    ds_read_b128 v[196:199], v5 offset:4416
    ds_write_addtid_b32 v212 offset:22304
    v_mul_f32 v237, v234, v221
    v_mul_f32 v240, v238, v226
    v_mul_f32 v241, v238, v227
    v_mfma_f32_16x16x32_bf16 v[200:203], a[68:71], v[172:175], v[200:203]
    v_fmac_f32 v232, v231, v252
    v_fmac_f32 v233, v231, v220
    v_fmac_f32 v236, v235, v252
    s_waitcnt lgkmcnt(10)
    v_mfma_f32_16x16x32_bf16 v[204:207], a[156:159], v[176:179], v[204:207]
    ds_read_b128 v[164:167], v5 offset:640
    v_fmac_f32 v237, v235, v220
    v_fma_f32 v240, -v239, v227, v240
    v_mfma_f32_16x16x32_bf16 v[200:203], a[132:135], v[176:179], v[200:203]
    v_fmac_f32 v241, v239, v226
    v_cvt_pk_bf16_f32 v213, v232, v233
    v_cvt_pk_bf16_f32 v214, v236, v237
    v_mfma_f32_16x16x32_bf16 v[204:207], a[220:223], v[180:183], v[204:207]
    ds_read_b128 v[168:171], v5 offset:1920
    v_cvt_pk_bf16_f32 v215, v240, -v241
    v_mfma_f32_16x16x32_bf16 v[200:203], a[196:199], v[180:183], v[200:203]
    ds_write_addtid_b32 v213 offset:5984
    ds_write_addtid_b32 v214 offset:14144
    v_mul_f32 v230, v232, v220
    s_waitcnt lgkmcnt(9)
    v_mfma_f32_16x16x32_bf16 v[204:207], a[24:27], v[184:187], v[204:207]
    ds_read_b128 v[172:175], v5 offset:3200
    ds_write_addtid_b32 v215 offset:22848
    v_mul_f32 v231, v232, v221
    v_mul_f32 v234, v236, v220
    v_mul_f32 v235, v236, v221
    v_mfma_f32_16x16x32_bf16 v[200:203], a[0:3], v[184:187], v[200:203]
    v_mul_f32 v238, v240, v226
    v_mul_f32 v239, v240, v227
    v_fmac_f32 v230, v233, v252
    v_mfma_f32_16x16x32_bf16 v[204:207], a[88:91], v[188:191], v[204:207]
    ds_read_b128 v[176:179], v5 offset:4480
    v_fmac_f32 v231, v233, v220
    v_fmac_f32 v234, v237, v252
    v_fmac_f32 v235, v237, v220
    v_mfma_f32_16x16x32_bf16 v[200:203], a[64:67], v[188:191], v[200:203]
    v_fma_f32 v238, -v241, v227, v238
    v_fmac_f32 v239, v241, v226
    s_waitcnt lgkmcnt(8)
    v_mfma_f32_16x16x32_bf16 v[204:207], a[152:155], v[192:195], v[204:207]
    ds_read_b128 v[180:183], v5 offset:704
    v_cvt_pk_bf16_f32 v208, v230, v231
    v_cvt_pk_bf16_f32 v209, v234, v235
    v_mfma_f32_16x16x32_bf16 v[200:203], a[128:131], v[192:195], v[200:203]
    ds_write_addtid_b32 v208 offset:6528
    v_cvt_pk_bf16_f32 v210, v238, -v239
    v_mul_f32 v232, v230, v220
    v_mfma_f32_16x16x32_bf16 v[204:207], a[216:219], v[196:199], v[204:207]
    ds_read_b128 v[184:187], v5 offset:1984
    ds_write_addtid_b32 v209 offset:14688
    v_mul_f32 v233, v230, v221
    v_mul_f32 v236, v234, v220
    v_mfma_f32_16x16x32_bf16 v[200:203], a[192:195], v[196:199], v[200:203]
    ds_write_addtid_b32 v210 offset:23392
    s_mov_b64 exec, s[92:93]
    buffer_load_dwordx4 v[120:123], v2, s[12:15], s72 offen sc1
    buffer_load_dwordx4 v[124:127], v3, s[12:15], s72 offen sc1
    s_mov_b64 exec, -1
    s_waitcnt lgkmcnt(10)
    v_mfma_f32_16x16x32_bf16 v[204:207], a[20:23], v[164:167], v[204:207]
    ds_read_b128 v[188:191], v5 offset:3264
    v_mul_f32 v237, v234, v221
    v_mul_f32 v240, v244, v228
    v_mul_f32 v241, v244, v229
    v_fmac_f32 v232, v231, v252
    v_mfma_f32_16x16x32_bf16 v[204:207], a[84:87], v[168:171], v[204:207]
    ds_read_b128 v[192:195], v5 offset:4544
    v_fmac_f32 v233, v231, v220
    v_fmac_f32 v236, v235, v252
    v_fmac_f32 v237, v235, v220
    v_fma_f32 v240, -v245, v229, v240
    s_waitcnt lgkmcnt(7)
    v_mfma_f32_16x16x32_bf16 v[204:207], a[148:151], v[172:175], v[204:207]
    ds_read_b128 v[196:199], v5 offset:768
    v_fmac_f32 v241, v245, v228
    v_cvt_pk_bf16_f32 v211, v232, v233
    v_cvt_pk_bf16_f32 v212, v236, v237
    v_mfma_f32_16x16x32_bf16 v[204:207], a[212:215], v[176:179], v[204:207]
    ds_read_b128 v[164:167], v5 offset:2048
    v_cvt_pk_bf16_f32 v213, v240, -v241
    s_waitcnt lgkmcnt(6)
    v_mfma_f32_16x16x32_bf16 v[204:207], a[16:19], v[180:183], v[204:207]
    ds_read_b128 v[168:171], v5 offset:3328
    ds_write_addtid_b32 v211 offset:7072
    v_mul_f32 v230, v232, v220
    v_mfma_f32_16x16x32_bf16 v[204:207], a[80:83], v[184:187], v[204:207]
    ds_read_b128 v[172:175], v5 offset:4608
    ds_write_addtid_b32 v212 offset:15232
    ds_write_addtid_b32 v213 offset:24480
    v_mul_f32 v231, v232, v221
    v_mul_f32 v234, v236, v220
    s_waitcnt lgkmcnt(7)
    v_mfma_f32_16x16x32_bf16 v[204:207], a[144:147], v[188:191], v[204:207]
    ds_read_b128 v[176:179], v5 offset:832
    v_mul_f32 v235, v236, v221
    v_mul_f32 v238, v246, v228
    v_mul_f32 v239, v246, v229
    v_mfma_f32_16x16x32_bf16 v[204:207], a[208:211], v[192:195], v[204:207]
    ds_read_b128 v[180:183], v5 offset:2112
    v_fmac_f32 v230, v233, v252
    v_fmac_f32 v231, v233, v220
    v_fmac_f32 v234, v237, v252
    s_waitcnt lgkmcnt(7)
    v_mfma_f32_16x16x32_bf16 v[204:207], a[12:15], v[196:199], v[204:207]
    ds_read_b128 v[184:187], v5 offset:3392
    v_fmac_f32 v235, v237, v220
    v_fma_f32 v238, -v247, v229, v238
    v_fmac_f32 v239, v247, v228
    v_mfma_f32_16x16x32_bf16 v[204:207], a[76:79], v[164:167], v[204:207]
    ds_read_b128 v[188:191], v5 offset:4672
    v_cvt_pk_bf16_f32 v214, v230, v231
    v_cvt_pk_bf16_f32 v215, v234, v235
    s_waitcnt lgkmcnt(6)
    v_mfma_f32_16x16x32_bf16 v[204:207], a[140:143], v[168:171], v[204:207]
    ds_read_b128 v[192:195], v5 offset:896
    ds_write_addtid_b32 v214 offset:7616
    v_cvt_pk_bf16_f32 v208, v238, -v239
    v_mfma_f32_16x16x32_bf16 v[204:207], a[204:207], v[172:175], v[204:207]
    ds_read_b128 v[196:199], v5 offset:2176
    ds_write_addtid_b32 v215 offset:15776
    v_mul_f32 v232, v230, v220
    v_mul_f32 v233, v230, v221
    s_waitcnt lgkmcnt(6)
    v_mfma_f32_16x16x32_bf16 v[204:207], a[8:11], v[176:179], v[204:207]
    ds_read_b128 v[164:167], v5 offset:3456
    ds_write_addtid_b32 v208 offset:25568
    v_mul_f32 v236, v234, v220
    v_mul_f32 v237, v234, v221
    v_fmac_f32 v232, v231, v252
    v_mfma_f32_16x16x32_bf16 v[204:207], a[72:75], v[180:183], v[204:207]
    ds_read_b128 v[168:171], v5 offset:4736
    v_fmac_f32 v233, v231, v220
    v_fmac_f32 v236, v235, v252
    v_fmac_f32 v237, v235, v220
    s_waitcnt lgkmcnt(7)
    v_mfma_f32_16x16x32_bf16 v[204:207], a[136:139], v[184:187], v[204:207]
    ds_read_b128 v[172:175], v5 offset:960
    v_cvt_pk_bf16_f32 v209, v232, v233
    v_cvt_pk_bf16_f32 v210, v236, v237
    v_mfma_f32_16x16x32_bf16 v[204:207], a[200:203], v[188:191], v[204:207]
    ds_read_b128 v[176:179], v5 offset:2240
    v_mul_f32 v234, v236, v220
    s_waitcnt lgkmcnt(6)
    v_mfma_f32_16x16x32_bf16 v[204:207], a[4:7], v[192:195], v[204:207]
    ds_read_b128 v[180:183], v5 offset:3520
    ds_write_addtid_b32 v209 offset:8160
    ds_write_addtid_b32 v210 offset:16320
    v_mul_f32 v235, v236, v221
    v_fmac_f32 v234, v237, v252
    v_mfma_f32_16x16x32_bf16 v[204:207], a[68:71], v[196:199], v[204:207]
    ds_read_b128 v[184:187], v5 offset:4800
    v_fmac_f32 v235, v237, v220
    v_cvt_pk_bf16_f32 v211, v234, v235
    s_waitcnt lgkmcnt(6)
    v_mfma_f32_16x16x32_bf16 v[204:207], a[132:135], v[164:167], v[204:207]
    ds_write_addtid_b32 v211 offset:16864
    v_cvt_pk_bf16_f32 v156, v200, v201
    v_mfma_f32_16x16x32_bf16 v[204:207], a[196:199], v[168:171], v[204:207]
    v_cvt_pk_bf16_f32 v157, v202, v203
    s_waitcnt lgkmcnt(5)
    v_mfma_f32_16x16x32_bf16 v[204:207], a[0:3], v[172:175], v[204:207]
    ds_write_b64 v7, v[156:157] offset:5120
    v_mfma_f32_16x16x32_bf16 v[204:207], a[64:67], v[176:179], v[204:207]
    s_waitcnt lgkmcnt(2)
    v_mfma_f32_16x16x32_bf16 v[204:207], a[128:131], v[180:183], v[204:207]
    v_mfma_f32_16x16x32_bf16 v[204:207], a[192:195], v[184:187], v[204:207]
    s_lshl_b32 s57, s84, 22
    s_add_u32 s73, s57, s79
    s_add_u32 s73, s73, 4194304
    s_add_u32 s74, s57, s80
    s_add_u32 s74, s74, 4194304
    s_add_u32 s75, s75, 4096
    s_nop 1
    v_cvt_pk_bf16_f32 v158, v204, v205
    v_cvt_pk_bf16_f32 v159, v206, v207
    ds_write_b64 v7, v[158:159] offset:8960
    s_branch L_ctailA
L_p1A_1:
    ds_read_b128 v[164:167], v5 offset:0
    ds_read_b128 v[168:171], v5 offset:1280
    ds_read_b128 v[172:175], v5 offset:2560
    ds_read_b128 v[176:179], v5 offset:3840
    ds_read_b128 v[180:183], v5 offset:64
    ds_read_b128 v[184:187], v5 offset:1344
    s_waitcnt lgkmcnt(5)
    v_mfma_f32_16x16x32_bf16 v[152:155], a[20:23], v[164:167], 0
    ds_read_b128 v[188:191], v5 offset:2624
    v_lshlrev_b32 v208, 16, v132
    v_lshlrev_b32 v209, 16, v133
    v_lshlrev_b32 v210, 16, v134
    v_mfma_f32_16x16x32_bf16 v[148:151], a[12:15], v[164:167], 0
    s_add_u32 s82, s79, 4194304
    buffer_store_dwordx4 v[12:15], v1, s[12:15], s82 offen sc1
    v_lshlrev_b32 v211, 16, v135
    v_lshlrev_b32 v212, 16, v136
    v_lshlrev_b32 v213, 16, v137
    s_waitcnt lgkmcnt(5)
    v_mfma_f32_16x16x32_bf16 v[152:155], a[84:87], v[168:171], v[152:155]
    ds_read_b128 v[192:195], v5 offset:3904
    v_lshlrev_b32 v214, 16, v138
    s_lshr_b32 s57, s5, 1
    s_mul_i32 s57, s57, 28832
    v_mfma_f32_16x16x32_bf16 v[148:151], a[76:79], v[168:171], v[148:151]
    s_lshl_b32 s58, s77, 8
    s_add_u32 s57, s57, s58
    s_waitcnt lgkmcnt(4)
    v_mfma_f32_16x16x32_bf16 v[152:155], a[148:151], v[172:175], v[152:155]
    ds_read_b128 v[196:199], v5 offset:128
    s_add_u32 s82, s79, 4194304
    buffer_store_dwordx4 v[12:15], v11, s[12:15], s82 offen sc1
    s_add_u32 m0, s57, 31744
    s_mov_b32 s57, 0x3fb8aa3b
    v_mfma_f32_16x16x32_bf16 v[148:151], a[140:143], v[172:175], v[148:151]
    s_mov_b32 s58, 0x32a57060
    v_mul_f32 v215, s57, v214
    v_fma_f32 v216, v214, s57, -v215
    v_exp_f32 v215, v215
    v_mfma_f32_16x16x32_bf16 v[152:155], a[212:215], v[176:179], v[152:155]
    ds_read_b128 v[164:167], v5 offset:1408
    v_fma_f32 v216, v214, s58, v216
    v_mul_f32 v216, 0x3f317218, v216
    v_fma_f32 v215, v215, v216, v215
    v_mfma_f32_16x16x32_bf16 v[148:151], a[204:207], v[176:179], v[148:151]
    v_cvt_pk_bf16_f32 v215, v215, v215
    v_and_b32 v215, 0xffff0000, v215
    s_waitcnt lgkmcnt(4)
    v_mfma_f32_16x16x32_bf16 v[152:155], a[16:19], v[180:183], v[152:155]
    ds_read_b128 v[168:171], v5 offset:2688
    v_mov_b32 v255, 0x3f80
    v_mul_f32 v208, v215, v208
    v_mul_f32 v209, v215, v209
    v_mfma_f32_16x16x32_bf16 v[148:151], a[8:11], v[180:183], v[148:151]
    v_mul_f32 v210, v215, v210
    v_mul_f32 v211, v215, v211
    v_mul_f32 v208, s57, v208
    v_mfma_f32_16x16x32_bf16 v[152:155], a[80:83], v[184:187], v[152:155]
    ds_read_b128 v[172:175], v5 offset:3968
    v_mul_f32 v209, 0.15915494, v209
    v_mul_f32 v216, v212, v210
    v_mul_f32 v217, v212, v211
    v_mfma_f32_16x16x32_bf16 v[148:151], a[72:75], v[184:187], v[148:151]
    v_fma_f32 v216, -v213, v211, v216
    v_fmac_f32 v217, v213, v210
    s_waitcnt lgkmcnt(4)
    v_mfma_f32_16x16x32_bf16 v[152:155], a[144:147], v[188:191], v[152:155]
    ds_read_b128 v[176:179], v5 offset:192
    ds_write_addtid_b32 v255
    v_mul_f32 v218, 1.0, v208
    v_mul_f32 v219, 1.0, v209
    v_mfma_f32_16x16x32_bf16 v[148:151], a[136:139], v[188:191], v[148:151]
    v_mul_f32 v220, 0x41000000, v208
    v_mul_f32 v221, 0x41000000, v209
    v_mul_f32 v222, 0x43000000, v208
    v_mfma_f32_16x16x32_bf16 v[152:155], a[208:211], v[192:195], v[152:155]
    ds_read_b128 v[180:183], v5 offset:1472
    v_mul_f32 v223, 0x43000000, v209
    v_mul_f32 v224, 0x43800000, v208
    v_mfma_f32_16x16x32_bf16 v[148:151], a[200:203], v[192:195], v[148:151]
    v_mul_f32 v225, 0x43800000, v209
    v_fract_f32 v219, v219
    v_exp_f32 v218, v218
    s_waitcnt lgkmcnt(5)
    v_mfma_f32_16x16x32_bf16 v[152:155], a[12:15], v[196:199], v[152:155]
    ds_read_b128 v[184:187], v5 offset:2752
    v_fract_f32 v221, v221
    v_exp_f32 v220, v220
    v_fract_f32 v223, v223
    v_mfma_f32_16x16x32_bf16 v[148:151], a[4:7], v[196:199], v[148:151]
    v_exp_f32 v222, v222
    v_fract_f32 v225, v225
    v_exp_f32 v224, v224
    v_mfma_f32_16x16x32_bf16 v[152:155], a[76:79], v[164:167], v[152:155]
    ds_read_b128 v[188:191], v5 offset:4032
    v_cos_f32 v208, v219
    v_sin_f32 v219, v219
    v_mfma_f32_16x16x32_bf16 v[148:151], a[68:71], v[164:167], v[148:151]
    v_cos_f32 v209, v221
    v_sin_f32 v221, v221
    v_cos_f32 v210, v223
    s_waitcnt lgkmcnt(5)
    v_mfma_f32_16x16x32_bf16 v[152:155], a[140:143], v[168:171], v[152:155]
    ds_read_b128 v[192:195], v5 offset:256
    v_sin_f32 v223, v223
    v_cos_f32 v211, v225
    v_sin_f32 v225, v225
    v_mfma_f32_16x16x32_bf16 v[148:151], a[132:135], v[168:171], v[148:151]
    v_mul_f32 v219, v218, v219
    v_mul_f32 v218, v218, v208
    v_mul_f32 v221, v220, v221
    v_mfma_f32_16x16x32_bf16 v[152:155], a[204:207], v[172:175], v[152:155]
    ds_read_b128 v[196:199], v5 offset:1536
    v_mul_f32 v220, v220, v209
    v_mul_f32 v223, v222, v223
    v_mfma_f32_16x16x32_bf16 v[148:151], a[196:199], v[172:175], v[148:151]
    v_mul_f32 v222, v222, v210
    v_mul_f32 v225, v224, v225
    v_mul_f32 v224, v224, v211
    s_waitcnt lgkmcnt(4)
    v_mfma_f32_16x16x32_bf16 v[152:155], a[8:11], v[176:179], v[152:155]
    ds_read_b128 v[164:167], v5 offset:2816
    v_sub_f32 v252, 0, v221
    v_sub_f32 v253, 0, v219
    v_sub_f32 v254, 0, v225
    v_mfma_f32_16x16x32_bf16 v[148:151], a[0:3], v[176:179], v[148:151]
    v_mul_f32 v226, v218, v218
    v_mul_f32 v227, v218, v219
    v_cvt_pk_bf16_f32 v208, v220, v221
    v_mfma_f32_16x16x32_bf16 v[152:155], a[72:75], v[180:183], v[152:155]
    ds_read_b128 v[168:171], v5 offset:4096
    v_fmac_f32 v226, v219, v253
    v_mfma_f32_16x16x32_bf16 v[148:151], a[64:67], v[180:183], v[148:151]
    ds_write_addtid_b32 v208 offset:544
    v_fmac_f32 v227, v219, v218
    v_mul_f32 v228, v226, v226
    v_mul_f32 v229, v226, v227
    s_waitcnt lgkmcnt(5)
    v_mfma_f32_16x16x32_bf16 v[152:155], a[136:139], v[184:187], v[152:155]
    ds_read_b128 v[172:175], v5 offset:320
    v_cvt_pk_bf16_f32 v209, v222, v223
    v_fma_f32 v228, -v227, v227, v228
    v_mfma_f32_16x16x32_bf16 v[148:151], a[128:131], v[184:187], v[148:151]
    ds_write_addtid_b32 v209 offset:8704
    v_fmac_f32 v229, v227, v226
    v_cvt_pk_bf16_f32 v210, v216, -v217
    v_mfma_f32_16x16x32_bf16 v[152:155], a[200:203], v[188:191], v[152:155]
    ds_read_b128 v[176:179], v5 offset:1600
    v_mul_f32 v230, v220, v220
    v_mul_f32 v231, v220, v221
    v_mfma_f32_16x16x32_bf16 v[148:151], a[192:195], v[188:191], v[148:151]
    ds_write_addtid_b32 v210 offset:17408
    v_mul_f32 v234, v222, v220
    v_mul_f32 v235, v222, v221
    v_mul_f32 v238, v216, v218
    s_waitcnt lgkmcnt(7)
    v_mfma_f32_16x16x32_bf16 v[152:155], a[4:7], v[192:195], v[152:155]
    ds_read_b128 v[180:183], v5 offset:2880
    v_mul_f32 v239, v216, v219
    v_mul_f32 v242, v216, v224
    v_mul_f32 v243, v216, v225
    v_mfma_f32_16x16x32_bf16 v[152:155], a[68:71], v[196:199], v[152:155]
    ds_read_b128 v[184:187], v5 offset:4160
    v_fmac_f32 v230, v221, v252
    v_fmac_f32 v231, v221, v220
    s_waitcnt lgkmcnt(7)
    v_mfma_f32_16x16x32_bf16 v[152:155], a[132:135], v[164:167], v[152:155]
    ds_read_b128 v[188:191], v5 offset:448
    v_cvt_pk_bf16_f32 v156, v148, v149
    v_fmac_f32 v234, v223, v252
    v_fmac_f32 v235, v223, v220
    v_fmac_f32 v238, v217, v253
    v_mfma_f32_16x16x32_bf16 v[152:155], a[196:199], v[168:171], v[152:155]
    ds_read_b128 v[192:195], v5 offset:1728
    v_cvt_pk_bf16_f32 v157, v150, v151
    v_fmac_f32 v239, v217, v218
    v_fmac_f32 v242, v217, v254
    v_fmac_f32 v243, v217, v224
    s_waitcnt lgkmcnt(5)
    v_mfma_f32_16x16x32_bf16 v[152:155], a[0:3], v[172:175], v[152:155]
    ds_read_b128 v[196:199], v5 offset:3008
    ds_write_b64 v7, v[156:157] offset:0
    v_cvt_pk_bf16_f32 v211, v230, v231
    v_cvt_pk_bf16_f32 v212, v234, v235
    v_mfma_f32_16x16x32_bf16 v[152:155], a[64:67], v[176:179], v[152:155]
    ds_read_b128 v[164:167], v5 offset:4288
    ds_write_addtid_b32 v211 offset:1088
    v_cvt_pk_bf16_f32 v213, v238, -v239
    s_waitcnt lgkmcnt(6)
    v_mfma_f32_16x16x32_bf16 v[152:155], a[128:131], v[180:183], v[152:155]
    ds_read_b128 v[168:171], v5 offset:384
    ds_write_addtid_b32 v212 offset:9248
    v_cvt_pk_bf16_f32 v214, v242, -v243
    v_mul_f32 v232, v230, v220
    v_mfma_f32_16x16x32_bf16 v[152:155], a[192:195], v[184:187], v[152:155]
    ds_read_b128 v[172:175], v5 offset:1664
    ds_write_addtid_b32 v213 offset:17952
    v_mul_f32 v233, v230, v221
    v_mul_f32 v236, v234, v220
    s_waitcnt lgkmcnt(8)
    v_mfma_f32_16x16x32_bf16 v[200:203], a[16:19], v[188:191], 0
    ds_read_b128 v[176:179], v5 offset:2944
    ds_read_b64_tr_b16 a[32:33], v6 offset:2080
    ds_write_addtid_b32 v214 offset:21760
    v_mul_f32 v237, v234, v221
    v_mul_f32 v240, v238, v218
    v_mfma_f32_16x16x32_bf16 v[204:207], a[24:27], v[188:191], 0
    ds_read_b64_tr_b16 a[34:35], v6 offset:2048
    v_mul_f32 v241, v238, v219
    v_mul_f32 v244, v242, v224
    v_mul_f32 v245, v242, v225
    v_mfma_f32_16x16x32_bf16 v[200:203], a[80:83], v[192:195], v[200:203]
    ds_read_b128 v[180:183], v5 offset:4224
    ds_read_b64_tr_b16 a[96:97], v6 offset:6240
    v_cvt_pk_bf16_f32 v158, v152, v153
    v_fmac_f32 v232, v231, v252
    v_fmac_f32 v233, v231, v220
    v_mfma_f32_16x16x32_bf16 v[204:207], a[88:91], v[192:195], v[204:207]
    ds_read_b64_tr_b16 a[98:99], v6 offset:6208
    v_cvt_pk_bf16_f32 v159, v154, v155
    v_fmac_f32 v236, v235, v252
    v_fmac_f32 v237, v235, v220
    v_fmac_f32 v240, v239, v253
    s_waitcnt lgkmcnt(12)
    v_mfma_f32_16x16x32_bf16 v[200:203], a[144:147], v[196:199], v[200:203]
    ds_read_b128 v[184:187], v5 offset:320
    ds_read_b64_tr_b16 a[160:161], v6 offset:10400
    ds_write_b64 v7, v[158:159] offset:1280
    v_fmac_f32 v241, v239, v218
    v_fmac_f32 v244, v243, v254
    v_mfma_f32_16x16x32_bf16 v[204:207], a[152:155], v[196:199], v[204:207]
    ds_read_b64_tr_b16 a[162:163], v6 offset:10368
    v_fmac_f32 v245, v243, v224
    v_cvt_pk_bf16_f32 v215, v232, v233
    v_cvt_pk_bf16_f32 v208, v236, v237
    v_mfma_f32_16x16x32_bf16 v[200:203], a[208:211], v[164:167], v[200:203]
    ds_read_b128 v[188:191], v5 offset:1600
    ds_read_b64_tr_b16 a[224:225], v6 offset:14560
    ds_write_addtid_b32 v215 offset:1632
    v_cvt_pk_bf16_f32 v209, v240, -v241
    v_cvt_pk_bf16_f32 v210, v244, -v245
    v_mfma_f32_16x16x32_bf16 v[204:207], a[216:219], v[164:167], v[204:207]
    ds_read_b64_tr_b16 a[226:227], v6 offset:14528
    ds_write_addtid_b32 v208 offset:9792
    v_mul_f32 v230, v232, v220
    s_waitcnt lgkmcnt(15)
    v_mfma_f32_16x16x32_bf16 v[200:203], a[20:23], v[168:171], v[200:203]
    ds_read_b128 v[192:195], v5 offset:2880
    ds_read_b64_tr_b16 a[36:37], v6 offset:2336
    ds_write_addtid_b32 v209 offset:18496
    ds_write_addtid_b32 v210 offset:23936
    s_waitcnt vmcnt(0)
    s_waitcnt lgkmcnt(10)
    s_barrier
    v_mfma_f32_16x16x32_bf16 v[204:207], a[28:31], v[168:171], v[204:207]
    ds_read_b64_tr_b16 a[38:39], v6 offset:2304
    ds_read_b128 v[160:163], v8
    v_mul_f32 v231, v232, v221
    v_mul_f32 v234, v236, v220
    v_mul_f32 v235, v236, v221
    v_mfma_f32_16x16x32_bf16 v[200:203], a[84:87], v[172:175], v[200:203]
    ds_read_b128 v[196:199], v5 offset:4160
    ds_read_b64_tr_b16 a[100:101], v6 offset:6496
    v_mul_f32 v238, v240, v218
    v_mul_f32 v239, v240, v219
    v_mul_f32 v246, v244, v224
    v_mfma_f32_16x16x32_bf16 v[204:207], a[92:95], v[172:175], v[204:207]
    ds_read_b64_tr_b16 a[102:103], v6 offset:6464
    v_mul_f32 v247, v244, v225
    v_fmac_f32 v230, v233, v252
    v_fmac_f32 v231, v233, v220
    v_fmac_f32 v234, v237, v252
    v_mfma_f32_16x16x32_bf16 v[200:203], a[148:151], v[176:179], v[200:203]
    ds_read_b128 v[164:167], v5 offset:256
    ds_read_b64_tr_b16 a[164:165], v6 offset:10656
    v_fmac_f32 v235, v237, v220
    v_fmac_f32 v238, v241, v253
    v_fmac_f32 v239, v241, v218
    v_mfma_f32_16x16x32_bf16 v[204:207], a[156:159], v[176:179], v[204:207]
    ds_read_b64_tr_b16 a[166:167], v6 offset:10624
    s_waitcnt lgkmcnt(6)
    buffer_store_dwordx4 v[160:163], v1, s[12:15], s75 offen sc1
    v_fmac_f32 v246, v245, v254
    v_fmac_f32 v247, v245, v224
    v_mfma_f32_16x16x32_bf16 v[200:203], a[212:215], v[180:183], v[200:203]
    ds_read_b128 v[168:171], v5 offset:1536
    ds_read_b64_tr_b16 a[228:229], v6 offset:14816
    v_cvt_pk_bf16_f32 v211, v230, v231
    v_cvt_pk_bf16_f32 v212, v234, v235
    v_cvt_pk_bf16_f32 v213, v238, -v239
    v_mfma_f32_16x16x32_bf16 v[204:207], a[220:223], v[180:183], v[204:207]
    ds_read_b64_tr_b16 a[230:231], v6 offset:14784
    ds_write_addtid_b32 v211 offset:2176
    v_cvt_pk_bf16_f32 v214, v246, -v247
    v_mfma_f32_16x16x32_bf16 v[200:203], a[24:27], v[184:187], v[200:203]
    ds_read_b128 v[172:175], v5 offset:2816
    ds_read_b64_tr_b16 a[40:41], v6 offset:2592
    ds_write_addtid_b32 v212 offset:10336
    v_mul_f32 v232, v230, v220
    v_mfma_f32_16x16x32_bf16 v[204:207], a[32:35], v[184:187], v[204:207]
    ds_read_b64_tr_b16 a[42:43], v6 offset:2560
    ds_write_addtid_b32 v213 offset:19040
    ds_write_addtid_b32 v214 offset:25024
    s_add_u32 s82, s81, 6291456
    buffer_store_dwordx4 v[12:15], v1, s[12:15], s82 offen sc1
    v_mfma_f32_16x16x32_bf16 v[200:203], a[88:91], v[188:191], v[200:203]
    ds_read_b128 v[176:179], v5 offset:4096
    ds_read_b64_tr_b16 a[104:105], v6 offset:6752
    v_mul_f32 v233, v230, v221
    v_mul_f32 v236, v234, v220
    v_mul_f32 v237, v234, v221
    v_mfma_f32_16x16x32_bf16 v[204:207], a[96:99], v[188:191], v[204:207]
    ds_read_b64_tr_b16 a[106:107], v6 offset:6720
    v_mul_f32 v240, v238, v218
    v_mul_f32 v241, v238, v219
    v_mul_f32 v248, v246, v224
    v_mul_f32 v249, v246, v225
    s_waitcnt lgkmcnt(15)
    v_mfma_f32_16x16x32_bf16 v[200:203], a[152:155], v[192:195], v[200:203]
    ds_read_b128 v[180:183], v5 offset:192
    ds_read_b64_tr_b16 a[168:169], v6 offset:10912
    v_fmac_f32 v232, v231, v252
    v_fmac_f32 v233, v231, v220
    v_fmac_f32 v236, v235, v252
    v_mfma_f32_16x16x32_bf16 v[204:207], a[160:163], v[192:195], v[204:207]
    ds_read_b64_tr_b16 a[170:171], v6 offset:10880
    v_fmac_f32 v237, v235, v220
    v_fmac_f32 v240, v239, v253
    v_fmac_f32 v241, v239, v218
    v_fmac_f32 v248, v247, v254
    v_mfma_f32_16x16x32_bf16 v[200:203], a[216:219], v[196:199], v[200:203]
    ds_read_b128 v[184:187], v5 offset:1472
    ds_read_b64_tr_b16 a[232:233], v6 offset:15072
    v_fmac_f32 v249, v247, v224
    v_cvt_pk_bf16_f32 v215, v232, v233
    v_cvt_pk_bf16_f32 v208, v236, v237
    v_mfma_f32_16x16x32_bf16 v[204:207], a[224:227], v[196:199], v[204:207]
    ds_read_b64_tr_b16 a[234:235], v6 offset:15040
    v_cvt_pk_bf16_f32 v209, v240, -v241
    s_waitcnt lgkmcnt(15)
    v_mfma_f32_16x16x32_bf16 v[200:203], a[28:31], v[164:167], v[200:203]
    ds_read_b128 v[188:191], v5 offset:2752
    ds_read_b64_tr_b16 a[44:45], v6 offset:2848
    ds_write_addtid_b32 v215 offset:2720
    v_cvt_pk_bf16_f32 v210, v248, -v249
    v_mfma_f32_16x16x32_bf16 v[204:207], a[36:39], v[164:167], v[204:207]
    ds_read_b64_tr_b16 a[46:47], v6 offset:2816
    ds_write_addtid_b32 v208 offset:10880
    ds_write_addtid_b32 v209 offset:19584
    v_mul_f32 v230, v232, v220
    v_mul_f32 v231, v232, v221
    v_mfma_f32_16x16x32_bf16 v[200:203], a[92:95], v[168:171], v[200:203]
    ds_read_b128 v[192:195], v5 offset:4032
    ds_read_b64_tr_b16 a[108:109], v6 offset:7008
    ds_write_addtid_b32 v210 offset:26112
    v_mul_f32 v234, v236, v220
    v_mul_f32 v235, v236, v221
    v_mfma_f32_16x16x32_bf16 v[204:207], a[100:103], v[168:171], v[204:207]
    ds_read_b64_tr_b16 a[110:111], v6 offset:6976
    s_add_u32 s82, s81, 6291456
    buffer_store_dwordx4 v[12:15], v11, s[12:15], s82 offen sc1
    v_mul_f32 v238, v240, v218
    v_mul_f32 v239, v240, v219
    s_waitcnt lgkmcnt(15)
    v_mfma_f32_16x16x32_bf16 v[200:203], a[156:159], v[172:175], v[200:203]
    ds_read_b128 v[196:199], v5 offset:128
    ds_read_b64_tr_b16 a[172:173], v6 offset:11168
    v_mul_f32 v250, v248, v224
    v_mul_f32 v251, v248, v225
    v_fmac_f32 v230, v233, v252
    v_mfma_f32_16x16x32_bf16 v[204:207], a[164:167], v[172:175], v[204:207]
    ds_read_b64_tr_b16 a[174:175], v6 offset:11136
    v_fmac_f32 v231, v233, v220
    v_fmac_f32 v234, v237, v252
    v_fmac_f32 v235, v237, v220
    v_fmac_f32 v238, v241, v253
    v_mfma_f32_16x16x32_bf16 v[200:203], a[220:223], v[176:179], v[200:203]
    ds_read_b128 v[164:167], v5 offset:1408
    ds_read_b64_tr_b16 a[236:237], v6 offset:15328
    v_fmac_f32 v239, v241, v218
    v_fmac_f32 v250, v249, v254
    v_mfma_f32_16x16x32_bf16 v[204:207], a[228:231], v[176:179], v[204:207]
    ds_read_b64_tr_b16 a[238:239], v6 offset:15296
    v_fmac_f32 v251, v249, v224
    v_cvt_pk_bf16_f32 v211, v230, v231
    v_cvt_pk_bf16_f32 v212, v234, v235
    s_waitcnt lgkmcnt(15)
    v_mfma_f32_16x16x32_bf16 v[200:203], a[32:35], v[180:183], v[200:203]
    ds_read_b128 v[168:171], v5 offset:2688
    ds_read_b64_tr_b16 a[48:49], v6 offset:3104
    v_cvt_pk_bf16_f32 v213, v238, -v239
    v_mfma_f32_16x16x32_bf16 v[204:207], a[40:43], v[180:183], v[204:207]
    ds_read_b64_tr_b16 a[50:51], v6 offset:3072
    ds_write_addtid_b32 v211 offset:3264
    ds_write_addtid_b32 v212 offset:11424
    v_cvt_pk_bf16_f32 v214, v250, -v251
    v_mul_f32 v232, v230, v220
    v_mfma_f32_16x16x32_bf16 v[200:203], a[96:99], v[184:187], v[200:203]
    ds_read_b128 v[172:175], v5 offset:3968
    ds_read_b64_tr_b16 a[112:113], v6 offset:7264
    ds_write_addtid_b32 v213 offset:20128
    v_mul_f32 v233, v230, v221
    v_mfma_f32_16x16x32_bf16 v[204:207], a[104:107], v[184:187], v[204:207]
    ds_read_b64_tr_b16 a[114:115], v6 offset:7232
    ds_write_addtid_b32 v214 offset:26656
    v_mul_f32 v236, v234, v220
    v_mul_f32 v237, v234, v221
    v_mul_f32 v240, v238, v218
    s_waitcnt lgkmcnt(15)
    v_mfma_f32_16x16x32_bf16 v[200:203], a[160:163], v[188:191], v[200:203]
    ds_read_b128 v[176:179], v5 offset:64
    ds_read_b64_tr_b16 a[176:177], v6 offset:11424
    v_mul_f32 v241, v238, v219
    v_mul_f32 v248, v250, v224
    v_mul_f32 v249, v250, v225
    v_mfma_f32_16x16x32_bf16 v[204:207], a[168:171], v[188:191], v[204:207]
    ds_read_b64_tr_b16 a[178:179], v6 offset:11392
    s_add_u32 s82, s81, 10485760
    buffer_store_dwordx4 v[12:15], v1, s[12:15], s82 offen sc1
    v_fmac_f32 v232, v231, v252
    v_fmac_f32 v233, v231, v220
    v_mfma_f32_16x16x32_bf16 v[200:203], a[224:227], v[192:195], v[200:203]
    ds_read_b128 v[180:183], v5 offset:1344
    ds_read_b64_tr_b16 a[240:241], v6 offset:15584
    v_fmac_f32 v236, v235, v252
    v_fmac_f32 v237, v235, v220
    v_fmac_f32 v240, v239, v253
    v_mfma_f32_16x16x32_bf16 v[204:207], a[232:235], v[192:195], v[204:207]
    ds_read_b64_tr_b16 a[242:243], v6 offset:15552
    v_fmac_f32 v241, v239, v218
    v_fmac_f32 v248, v251, v254
    v_fmac_f32 v249, v251, v224
    s_waitcnt lgkmcnt(15)
    v_mfma_f32_16x16x32_bf16 v[200:203], a[36:39], v[196:199], v[200:203]
    ds_read_b128 v[184:187], v5 offset:2624
    ds_read_b64_tr_b16 a[52:53], v6 offset:3360
    v_cvt_pk_bf16_f32 v215, v232, v233
    v_cvt_pk_bf16_f32 v208, v236, v237
    v_mfma_f32_16x16x32_bf16 v[204:207], a[44:47], v[196:199], v[204:207]
    ds_read_b64_tr_b16 a[54:55], v6 offset:3328
    ds_write_addtid_b32 v215 offset:3808
    v_cvt_pk_bf16_f32 v209, v240, -v241
    v_cvt_pk_bf16_f32 v210, v248, -v249
    v_mfma_f32_16x16x32_bf16 v[200:203], a[100:103], v[164:167], v[200:203]
    ds_read_b128 v[188:191], v5 offset:3904
    ds_read_b64_tr_b16 a[116:117], v6 offset:7520
    ds_write_addtid_b32 v208 offset:11968
    v_mul_f32 v230, v232, v220
    v_mfma_f32_16x16x32_bf16 v[204:207], a[108:111], v[164:167], v[204:207]
    ds_read_b64_tr_b16 a[118:119], v6 offset:7488
    ds_write_addtid_b32 v209 offset:20672
    v_mul_f32 v231, v232, v221
    v_mul_f32 v234, v236, v220
    s_waitcnt lgkmcnt(15)
    v_mfma_f32_16x16x32_bf16 v[200:203], a[164:167], v[168:171], v[200:203]
    ds_read_b128 v[192:195], v5 offset:0
    ds_read_b64_tr_b16 a[180:181], v6 offset:11680
    ds_write_addtid_b32 v210 offset:27200
    v_mul_f32 v235, v236, v221
    v_mul_f32 v238, v240, v218
    v_mfma_f32_16x16x32_bf16 v[204:207], a[172:175], v[168:171], v[204:207]
    ds_read_b64_tr_b16 a[182:183], v6 offset:11648
    v_mul_f32 v239, v240, v219
    v_mul_f32 v250, v248, v224
    v_mul_f32 v251, v248, v225
    v_mfma_f32_16x16x32_bf16 v[200:203], a[228:231], v[172:175], v[200:203]
    ds_read_b128 v[196:199], v5 offset:1280
    ds_read_b64_tr_b16 a[244:245], v6 offset:15840
    v_fmac_f32 v230, v233, v252
    v_fmac_f32 v231, v233, v220
    v_fmac_f32 v234, v237, v252
    v_mfma_f32_16x16x32_bf16 v[204:207], a[236:239], v[172:175], v[204:207]
    ds_read_b64_tr_b16 a[246:247], v6 offset:15808
    s_add_u32 s82, s81, 10485760
    buffer_store_dwordx4 v[12:15], v11, s[12:15], s82 offen sc1
    v_fmac_f32 v235, v237, v220
    v_fmac_f32 v238, v241, v253
    s_waitcnt lgkmcnt(15)
    v_mfma_f32_16x16x32_bf16 v[200:203], a[40:43], v[176:179], v[200:203]
    ds_read_b128 v[164:167], v5 offset:2560
    v_fmac_f32 v239, v241, v218
    v_fmac_f32 v250, v249, v254
    v_fmac_f32 v251, v249, v224
    v_cvt_pk_bf16_f32 v211, v230, v231
    v_mfma_f32_16x16x32_bf16 v[204:207], a[48:51], v[176:179], v[204:207]
    v_cvt_pk_bf16_f32 v212, v234, v235
    v_cvt_pk_bf16_f32 v213, v238, -v239
    v_mfma_f32_16x16x32_bf16 v[200:203], a[104:107], v[180:183], v[200:203]
    ds_read_b128 v[168:171], v5 offset:3840
    ds_write_addtid_b32 v211 offset:4352
    v_cvt_pk_bf16_f32 v214, v250, -v251
    v_mfma_f32_16x16x32_bf16 v[204:207], a[112:115], v[180:183], v[204:207]
    ds_write_addtid_b32 v212 offset:12512
    v_mul_f32 v232, v230, v220
    s_waitcnt lgkmcnt(15)
    v_mfma_f32_16x16x32_bf16 v[200:203], a[168:171], v[184:187], v[200:203]
    ds_read_b128 v[172:175], v5 offset:512
    ds_write_addtid_b32 v213 offset:21216
    ds_write_addtid_b32 v214 offset:27744
    v_mul_f32 v233, v230, v221
    v_mul_f32 v236, v234, v220
    v_mfma_f32_16x16x32_bf16 v[204:207], a[176:179], v[184:187], v[204:207]
    v_mul_f32 v237, v234, v221
    v_mul_f32 v248, v250, v224
    v_mul_f32 v249, v250, v225
    v_mfma_f32_16x16x32_bf16 v[200:203], a[232:235], v[188:191], v[200:203]
    ds_read_b128 v[176:179], v5 offset:1792
    v_fmac_f32 v232, v231, v252
    v_fmac_f32 v233, v231, v220
    v_fmac_f32 v236, v235, v252
    v_mfma_f32_16x16x32_bf16 v[204:207], a[240:243], v[188:191], v[204:207]
    v_fmac_f32 v237, v235, v220
    v_fmac_f32 v248, v251, v254
    v_fmac_f32 v249, v251, v224
    s_waitcnt lgkmcnt(10)
    v_mfma_f32_16x16x32_bf16 v[200:203], a[44:47], v[192:195], v[200:203]
    ds_read_b128 v[180:183], v5 offset:3072
    v_cvt_pk_bf16_f32 v215, v232, v233
    v_cvt_pk_bf16_f32 v208, v236, v237
    v_mfma_f32_16x16x32_bf16 v[204:207], a[52:55], v[192:195], v[204:207]
    v_cvt_pk_bf16_f32 v209, v248, -v249
    v_mul_f32 v230, v232, v220
    v_mfma_f32_16x16x32_bf16 v[200:203], a[108:111], v[196:199], v[200:203]
    ds_read_b128 v[184:187], v5 offset:4352
    ds_write_addtid_b32 v215 offset:4896
    ds_write_addtid_b32 v208 offset:13056
    v_mul_f32 v231, v232, v221
    v_mfma_f32_16x16x32_bf16 v[204:207], a[116:119], v[196:199], v[204:207]
    ds_write_addtid_b32 v209 offset:28288
    v_mul_f32 v234, v236, v220
    v_mul_f32 v235, v236, v221
    v_mul_f32 v238, v242, v226
    s_waitcnt lgkmcnt(11)
    v_mfma_f32_16x16x32_bf16 v[200:203], a[172:175], v[164:167], v[200:203]
    ds_read_b128 v[188:191], v5 offset:576
    v_mul_f32 v239, v242, v227
    v_fmac_f32 v230, v233, v252
    v_mfma_f32_16x16x32_bf16 v[204:207], a[180:183], v[164:167], v[204:207]
    v_fmac_f32 v231, v233, v220
    v_fmac_f32 v234, v237, v252
    v_fmac_f32 v235, v237, v220
    v_mfma_f32_16x16x32_bf16 v[200:203], a[236:239], v[168:171], v[200:203]
    ds_read_b128 v[192:195], v5 offset:1856
    v_fma_f32 v238, -v243, v227, v238
    v_fmac_f32 v239, v243, v226
    v_cvt_pk_bf16_f32 v210, v230, v231
    v_mfma_f32_16x16x32_bf16 v[204:207], a[244:247], v[168:171], v[204:207]
    v_cvt_pk_bf16_f32 v211, v234, v235
    v_cvt_pk_bf16_f32 v212, v238, -v239
    s_waitcnt lgkmcnt(7)
    v_mfma_f32_16x16x32_bf16 v[204:207], a[20:23], v[172:175], v[204:207]
    ds_read_b128 v[196:199], v5 offset:3136
    ds_write_addtid_b32 v210 offset:5440
    v_mul_f32 v232, v230, v220
    v_mfma_f32_16x16x32_bf16 v[200:203], a[12:15], v[172:175], v[200:203]
    ds_write_addtid_b32 v211 offset:13600
    v_mul_f32 v233, v230, v221
    v_mul_f32 v236, v234, v220
    v_mfma_f32_16x16x32_bf16 v[204:207], a[84:87], v[176:179], v[204:207]
    ds_read_b128 v[164:167], v5 offset:4416
    ds_write_addtid_b32 v212 offset:22304
    v_mul_f32 v237, v234, v221
    v_mul_f32 v240, v238, v226
    v_mul_f32 v241, v238, v227
    v_mfma_f32_16x16x32_bf16 v[200:203], a[76:79], v[176:179], v[200:203]
    v_fmac_f32 v232, v231, v252
    v_fmac_f32 v233, v231, v220
    v_fmac_f32 v236, v235, v252
    s_waitcnt lgkmcnt(10)
    v_mfma_f32_16x16x32_bf16 v[204:207], a[148:151], v[180:183], v[204:207]
    ds_read_b128 v[168:171], v5 offset:640
    v_fmac_f32 v237, v235, v220
    v_fma_f32 v240, -v239, v227, v240
    v_mfma_f32_16x16x32_bf16 v[200:203], a[140:143], v[180:183], v[200:203]
    v_fmac_f32 v241, v239, v226
    v_cvt_pk_bf16_f32 v213, v232, v233
    v_cvt_pk_bf16_f32 v214, v236, v237
    v_mfma_f32_16x16x32_bf16 v[204:207], a[212:215], v[184:187], v[204:207]
    ds_read_b128 v[172:175], v5 offset:1920
    v_cvt_pk_bf16_f32 v215, v240, -v241
    v_mfma_f32_16x16x32_bf16 v[200:203], a[204:207], v[184:187], v[200:203]
    ds_write_addtid_b32 v213 offset:5984
    ds_write_addtid_b32 v214 offset:14144
    v_mul_f32 v230, v232, v220
    s_waitcnt lgkmcnt(9)
    v_mfma_f32_16x16x32_bf16 v[204:207], a[16:19], v[188:191], v[204:207]
    ds_read_b128 v[176:179], v5 offset:3200
    ds_write_addtid_b32 v215 offset:22848
    v_mul_f32 v231, v232, v221
    v_mul_f32 v234, v236, v220
    v_mul_f32 v235, v236, v221
    v_mfma_f32_16x16x32_bf16 v[200:203], a[8:11], v[188:191], v[200:203]
    v_mul_f32 v238, v240, v226
    v_mul_f32 v239, v240, v227
    v_fmac_f32 v230, v233, v252
    v_mfma_f32_16x16x32_bf16 v[204:207], a[80:83], v[192:195], v[204:207]
    ds_read_b128 v[180:183], v5 offset:4480
    v_fmac_f32 v231, v233, v220
    v_fmac_f32 v234, v237, v252
    v_fmac_f32 v235, v237, v220
    v_mfma_f32_16x16x32_bf16 v[200:203], a[72:75], v[192:195], v[200:203]
    v_fma_f32 v238, -v241, v227, v238
    v_fmac_f32 v239, v241, v226
    s_waitcnt lgkmcnt(8)
    v_mfma_f32_16x16x32_bf16 v[204:207], a[144:147], v[196:199], v[204:207]
    ds_read_b128 v[184:187], v5 offset:704
    v_cvt_pk_bf16_f32 v208, v230, v231
    v_cvt_pk_bf16_f32 v209, v234, v235
    v_mfma_f32_16x16x32_bf16 v[200:203], a[136:139], v[196:199], v[200:203]
    ds_write_addtid_b32 v208 offset:6528
    v_cvt_pk_bf16_f32 v210, v238, -v239
    v_mul_f32 v232, v230, v220
    v_mfma_f32_16x16x32_bf16 v[204:207], a[208:211], v[164:167], v[204:207]
    ds_read_b128 v[188:191], v5 offset:1984
    ds_write_addtid_b32 v209 offset:14688
    v_mul_f32 v233, v230, v221
    v_mul_f32 v236, v234, v220
    v_mfma_f32_16x16x32_bf16 v[200:203], a[200:203], v[164:167], v[200:203]
    ds_write_addtid_b32 v210 offset:23392
    s_mov_b64 exec, s[92:93]
    buffer_load_dwordx4 v[120:123], v2, s[12:15], s72 offen sc1
    buffer_load_dwordx4 v[124:127], v3, s[12:15], s72 offen sc1
    s_mov_b64 exec, -1
    s_waitcnt lgkmcnt(10)
    v_mfma_f32_16x16x32_bf16 v[204:207], a[12:15], v[168:171], v[204:207]
    ds_read_b128 v[192:195], v5 offset:3264
    v_mul_f32 v237, v234, v221
    v_mul_f32 v240, v244, v228
    v_mul_f32 v241, v244, v229
    v_fmac_f32 v232, v231, v252
    v_mfma_f32_16x16x32_bf16 v[200:203], a[4:7], v[168:171], v[200:203]
    v_fmac_f32 v233, v231, v220
    v_fmac_f32 v236, v235, v252
    v_fmac_f32 v237, v235, v220
    v_fma_f32 v240, -v245, v229, v240
    v_mfma_f32_16x16x32_bf16 v[204:207], a[76:79], v[172:175], v[204:207]
    ds_read_b128 v[196:199], v5 offset:4544
    v_fmac_f32 v241, v245, v228
    v_cvt_pk_bf16_f32 v211, v232, v233
    v_cvt_pk_bf16_f32 v212, v236, v237
    v_mfma_f32_16x16x32_bf16 v[200:203], a[68:71], v[172:175], v[200:203]
    v_cvt_pk_bf16_f32 v213, v240, -v241
    v_mul_f32 v230, v232, v220
    s_waitcnt lgkmcnt(7)
    v_mfma_f32_16x16x32_bf16 v[204:207], a[140:143], v[176:179], v[204:207]
    ds_read_b128 v[164:167], v5 offset:768
    ds_write_addtid_b32 v211 offset:7072
    ds_write_addtid_b32 v212 offset:15232
    v_mfma_f32_16x16x32_bf16 v[200:203], a[132:135], v[176:179], v[200:203]
    ds_write_addtid_b32 v213 offset:24480
    v_mul_f32 v231, v232, v221
    v_mul_f32 v234, v236, v220
    v_mul_f32 v235, v236, v221
    v_mfma_f32_16x16x32_bf16 v[204:207], a[204:207], v[180:183], v[204:207]
    ds_read_b128 v[168:171], v5 offset:2048
    v_mul_f32 v238, v246, v228
    v_mul_f32 v239, v246, v229
    v_mfma_f32_16x16x32_bf16 v[200:203], a[196:199], v[180:183], v[200:203]
    v_fmac_f32 v230, v233, v252
    v_fmac_f32 v231, v233, v220
    v_fmac_f32 v234, v237, v252
    s_waitcnt lgkmcnt(9)
    v_mfma_f32_16x16x32_bf16 v[204:207], a[8:11], v[184:187], v[204:207]
    ds_read_b128 v[172:175], v5 offset:3328
    v_fmac_f32 v235, v237, v220
    v_fma_f32 v238, -v247, v229, v238
    v_fmac_f32 v239, v247, v228
    v_mfma_f32_16x16x32_bf16 v[200:203], a[0:3], v[184:187], v[200:203]
    v_cvt_pk_bf16_f32 v214, v230, v231
    v_cvt_pk_bf16_f32 v215, v234, v235
    v_mfma_f32_16x16x32_bf16 v[204:207], a[72:75], v[188:191], v[204:207]
    ds_read_b128 v[176:179], v5 offset:4608
    ds_write_addtid_b32 v214 offset:7616
    v_cvt_pk_bf16_f32 v208, v238, -v239
    v_mfma_f32_16x16x32_bf16 v[200:203], a[64:67], v[188:191], v[200:203]
    ds_write_addtid_b32 v215 offset:15776
    v_mul_f32 v232, v230, v220
    v_mul_f32 v233, v230, v221
    s_waitcnt lgkmcnt(9)
    v_mfma_f32_16x16x32_bf16 v[204:207], a[136:139], v[192:195], v[204:207]
    ds_read_b128 v[180:183], v5 offset:832
    ds_write_addtid_b32 v208 offset:25568
    v_mul_f32 v236, v234, v220
    v_mul_f32 v237, v234, v221
    v_fmac_f32 v232, v231, v252
    v_mfma_f32_16x16x32_bf16 v[200:203], a[128:131], v[192:195], v[200:203]
    v_fmac_f32 v233, v231, v220
    v_fmac_f32 v236, v235, v252
    v_fmac_f32 v237, v235, v220
    v_mfma_f32_16x16x32_bf16 v[204:207], a[200:203], v[196:199], v[204:207]
    ds_read_b128 v[184:187], v5 offset:2112
    v_cvt_pk_bf16_f32 v209, v232, v233
    v_cvt_pk_bf16_f32 v210, v236, v237
    v_mfma_f32_16x16x32_bf16 v[200:203], a[192:195], v[196:199], v[200:203]
    v_mul_f32 v234, v236, v220
    v_mul_f32 v235, v236, v221
    s_waitcnt lgkmcnt(7)
    v_mfma_f32_16x16x32_bf16 v[204:207], a[4:7], v[164:167], v[204:207]
    ds_read_b128 v[188:191], v5 offset:3392
    ds_write_addtid_b32 v209 offset:8160
    ds_write_addtid_b32 v210 offset:16320
    v_fmac_f32 v234, v237, v252
    v_fmac_f32 v235, v237, v220
    v_mfma_f32_16x16x32_bf16 v[204:207], a[68:71], v[168:171], v[204:207]
    ds_read_b128 v[192:195], v5 offset:4672
    v_cvt_pk_bf16_f32 v211, v234, v235
    s_waitcnt lgkmcnt(9)
    v_mfma_f32_16x16x32_bf16 v[204:207], a[132:135], v[172:175], v[204:207]
    ds_write_addtid_b32 v211 offset:16864
    v_cvt_pk_bf16_f32 v156, v200, v201
    v_mfma_f32_16x16x32_bf16 v[204:207], a[196:199], v[176:179], v[204:207]
    v_cvt_pk_bf16_f32 v157, v202, v203
    s_waitcnt lgkmcnt(5)
    v_mfma_f32_16x16x32_bf16 v[204:207], a[0:3], v[180:183], v[204:207]
    ds_write_b64 v7, v[156:157] offset:5120
    v_mfma_f32_16x16x32_bf16 v[204:207], a[64:67], v[184:187], v[204:207]
    s_waitcnt lgkmcnt(2)
    v_mfma_f32_16x16x32_bf16 v[204:207], a[128:131], v[188:191], v[204:207]
    v_mfma_f32_16x16x32_bf16 v[204:207], a[192:195], v[192:195], v[204:207]
    s_lshl_b32 s57, s84, 22
    s_add_u32 s73, s57, s79
    s_add_u32 s73, s73, 4194304
    s_add_u32 s74, s57, s80
    s_add_u32 s74, s74, 4194304
    s_add_u32 s75, s75, 4096
    s_nop 1
    v_cvt_pk_bf16_f32 v158, v204, v205
    v_cvt_pk_bf16_f32 v159, v206, v207
    ds_write_b64 v7, v[158:159] offset:6400
L_ctailA:
    s_waitcnt lgkmcnt(0)
    s_barrier
    ds_read_b128 v[160:163], v8 offset:5120
    s_waitcnt lgkmcnt(0)
    buffer_store_dwordx4 v[160:163], v1, s[12:15], s75 offen sc1
    s_add_u32 s75, s57, s81
    s_add_u32 s75, s75, 6291456
    s_add_u32 s84, s84, 1
    s_cmp_eq_u32 s6, 0
    s_cbranch_scc1 L_r2
    s_call_b64 s[60:61], L_kg2
    s_call_b64 s[60:61], L_kfrag
    s_waitcnt vmcnt(0)
    v_mov_b32 v12, -1
    v_mov_b32 v13, -1
    v_mov_b32 v14, -1
    v_mov_b32 v15, -1
    s_add_u32 s82, s79, 8388608
    buffer_store_dwordx4 v[12:15], v1, s[12:15], s82 offen sc1
    buffer_store_dwordx4 v[12:15], v11, s[12:15], s82 offen sc1
    s_branch L_r2b
L_r2:
    s_waitcnt vmcnt(1)
L_r2b:
L_r2_chk_9:
    s_nop 0
    v_max3_u32 v12, v120, v121, v122
    v_max3_u32 v12, v12, v123, v124
    v_max3_u32 v12, v12, v125, v126
    v_max_u32 v12, v12, v127
    v_cmp_eq_u32 vcc, -1, v12
    s_nop 0
    s_cbranch_vccnz L_r2_rt_10
L_r2_ok_11:
    v_dot2_f32_bf16 v32, v120, s64, v64
    v_dot2_f32_bf16 v33, v124, s64, v65
    v_dot2_f32_bf16 v34, v120, s65, v66
    v_dot2_f32_bf16 v35, v124, s65, v67
    v_dot2_f32_bf16 v36, v121, s64, v68
    v_dot2_f32_bf16 v37, v125, s64, v69
    v_dot2_f32_bf16 v38, v121, s65, v70
    v_dot2_f32_bf16 v39, v125, s65, v71
    v_dot2_f32_bf16 v40, v122, s64, v72
    v_dot2_f32_bf16 v41, v126, s64, v73
    v_dot2_f32_bf16 v42, v122, s65, v74
    v_dot2_f32_bf16 v43, v126, s65, v75
    v_dot2_f32_bf16 v44, v123, s64, v76
    v_dot2_f32_bf16 v45, v127, s64, v77
    v_dot2_f32_bf16 v46, v123, s65, v78
    v_dot2_f32_bf16 v47, v127, s65, v79
    v_pk_fma_f32 v[88:89], v[48:49], v[32:33], v[16:17]
    v_pk_fma_f32 v[90:91], v[50:51], v[34:35], v[18:19]
    v_pk_fma_f32 v[92:93], v[52:53], v[36:37], v[20:21]
    v_pk_fma_f32 v[94:95], v[54:55], v[38:39], v[22:23]
    v_pk_fma_f32 v[96:97], v[56:57], v[40:41], v[24:25]
    v_pk_fma_f32 v[98:99], v[58:59], v[42:43], v[26:27]
    v_pk_fma_f32 v[100:101], v[60:61], v[44:45], v[28:29]
    v_pk_fma_f32 v[102:103], v[62:63], v[46:47], v[30:31]
    v_cvt_pk_bf16_f32 v80, v88, v89
    v_cvt_pk_bf16_f32 v81, v90, v91
    v_cvt_pk_bf16_f32 v82, v92, v93
    v_cvt_pk_bf16_f32 v83, v94, v95
    v_cvt_pk_bf16_f32 v84, v96, v97
    v_cvt_pk_bf16_f32 v85, v98, v99
    v_cvt_pk_bf16_f32 v86, v100, v101
    v_cvt_pk_bf16_f32 v87, v102, v103
    v_dot2_f32_bf16 v88, v80, s66, 0
    v_dot2_f32_bf16 v89, v81, s66, 0
    v_dot2_f32_bf16 v90, v82, s66, 0
    v_dot2_f32_bf16 v91, v83, s66, 0
    v_dot2_f32_bf16 v92, v84, s66, 0
    v_dot2_f32_bf16 v93, v85, s66, 0
    v_dot2_f32_bf16 v94, v86, s66, 0
    v_dot2_f32_bf16 v95, v87, s66, 0
    v_dot2_f32_bf16 v96, v80, v80, 0
    v_dot2_f32_bf16 v97, v81, v81, 0
    v_dot2_f32_bf16 v98, v82, v82, 0
    v_dot2_f32_bf16 v99, v83, v83, 0
    v_dot2_f32_bf16 v100, v84, v84, 0
    v_dot2_f32_bf16 v101, v85, v85, 0
    v_dot2_f32_bf16 v102, v86, v86, 0
    v_dot2_f32_bf16 v103, v87, v87, 0
    v_add_f32_dpp v88, v88, v88 row_shl:8 row_mask:0xf bank_mask:0x3
    v_add_f32_dpp v89, v89, v89 row_shl:8 row_mask:0xf bank_mask:0x3
    v_add_f32_dpp v90, v90, v90 row_shl:8 row_mask:0xf bank_mask:0x3
    v_add_f32_dpp v91, v91, v91 row_shl:8 row_mask:0xf bank_mask:0x3
    v_add_f32_dpp v92, v92, v92 row_shl:8 row_mask:0xf bank_mask:0x3
    v_add_f32_dpp v93, v93, v93 row_shl:8 row_mask:0xf bank_mask:0x3
    v_add_f32_dpp v94, v94, v94 row_shl:8 row_mask:0xf bank_mask:0x3
    v_add_f32_dpp v95, v95, v95 row_shl:8 row_mask:0xf bank_mask:0x3
    v_add_f32_dpp v88, v96, v96 row_shr:8 row_mask:0xf bank_mask:0xc
    v_add_f32_dpp v89, v97, v97 row_shr:8 row_mask:0xf bank_mask:0xc
    v_add_f32_dpp v90, v98, v98 row_shr:8 row_mask:0xf bank_mask:0xc
    v_add_f32_dpp v91, v99, v99 row_shr:8 row_mask:0xf bank_mask:0xc
    v_add_f32_dpp v92, v100, v100 row_shr:8 row_mask:0xf bank_mask:0xc
    v_add_f32_dpp v93, v101, v101 row_shr:8 row_mask:0xf bank_mask:0xc
    v_add_f32_dpp v94, v102, v102 row_shr:8 row_mask:0xf bank_mask:0xc
    v_add_f32_dpp v95, v103, v103 row_shr:8 row_mask:0xf bank_mask:0xc
    v_add_f32_dpp v88, v88, v88 row_shl:4 row_mask:0xf bank_mask:0x5
    v_add_f32_dpp v89, v89, v89 row_shl:4 row_mask:0xf bank_mask:0x5
    v_add_f32_dpp v90, v90, v90 row_shl:4 row_mask:0xf bank_mask:0x5
    v_add_f32_dpp v91, v91, v91 row_shl:4 row_mask:0xf bank_mask:0x5
    v_add_f32_dpp v88, v92, v92 row_shr:4 row_mask:0xf bank_mask:0xa
    v_add_f32_dpp v89, v93, v93 row_shr:4 row_mask:0xf bank_mask:0xa
    v_add_f32_dpp v90, v94, v94 row_shr:4 row_mask:0xf bank_mask:0xa
    v_add_f32_dpp v91, v95, v95 row_shr:4 row_mask:0xf bank_mask:0xa
    v_lshlrev_b32 v16, 16, v80
    v_permlane16_swap_b32 v88, v90
    v_permlane16_swap_b32 v89, v91
    v_add_f32 v88, v88, v90
    v_add_f32 v89, v89, v91
    v_and_b32 v17, 0xffff0000, v80
    v_lshlrev_b32 v18, 16, v81
    v_permlane32_swap_b32 v88, v89
    v_add_f32 v88, v88, v89
    v_and_b32 v19, 0xffff0000, v81
    v_lshlrev_b32 v20, 16, v82
    v_add_f32_dpp v88, v88, v88 quad_perm:[1,0,3,2] row_mask:0xf bank_mask:0xf
    v_and_b32 v21, 0xffff0000, v82
    v_lshlrev_b32 v22, 16, v83
    v_add_f32_dpp v88, v88, v88 quad_perm:[2,3,0,1] row_mask:0xf bank_mask:0xf
    ds_write_b32 v9, v88
    v_and_b32 v23, 0xffff0000, v83
    v_lshlrev_b32 v24, 16, v84
    v_and_b32 v25, 0xffff0000, v84
    v_lshlrev_b32 v26, 16, v85
    v_and_b32 v27, 0xffff0000, v85
    v_lshlrev_b32 v28, 16, v86
    v_and_b32 v29, 0xffff0000, v86
    v_lshlrev_b32 v30, 16, v87
    v_and_b32 v31, 0xffff0000, v87
    s_waitcnt lgkmcnt(0)
    s_barrier
    ds_read_b128 v[88:91], v10
    ds_read_b128 v[92:95], v10 offset:16
    s_cmp_eq_u32 s6, 0
    s_cbranch_scc1 L_hc_12
    buffer_load_dwordx4 v[144:147], v2, s[12:15], s74 offen sc1
L_hc_12:
    v_xor_b32 v9, 256, v9
    v_xor_b32 v10, 256, v10
    s_waitcnt lgkmcnt(1)
    v_add_f32 v88, v88, v89
    v_add_f32 v90, v90, v91
    s_waitcnt lgkmcnt(0)
    v_add_f32 v92, v92, v93
    v_add_f32 v94, v94, v95
    v_add_f32 v88, v88, v90
    v_add_f32 v92, v92, v94
    v_mul_f32 v88, s83, v88
    v_mul_f32 v92, s83, v92
    v_fma_f32 v92, -v88, v88, v92
    v_max_f32 v92, 0, v92
    v_add_f32 v92, 0x3727c5ac, v92
    v_rsq_f32 v13, v92
    s_nop 0
    s_nop 0
    v_mul_f32_e64 v12, -v88, v13
    v_readlane_b32 s16, v13, 0
    v_readlane_b32 s17, v12, 0
    v_readlane_b32 s18, v13, 1
    v_readlane_b32 s19, v12, 1
    v_readlane_b32 s20, v13, 2
    v_readlane_b32 s21, v12, 2
    v_readlane_b32 s22, v13, 3
    v_readlane_b32 s23, v12, 3
    v_readlane_b32 s24, v13, 4
    v_readlane_b32 s25, v12, 4
    v_readlane_b32 s26, v13, 5
    v_readlane_b32 s27, v12, 5
    v_readlane_b32 s28, v13, 6
    v_readlane_b32 s29, v12, 6
    v_readlane_b32 s30, v13, 7
    v_readlane_b32 s31, v12, 7
    v_pk_fma_f32 v[104:105], v[16:17], s[16:17], s[16:17] op_sel:[0,0,1] op_sel_hi:[1,0,1]
    v_pk_fma_f32 v[106:107], v[18:19], s[18:19], s[18:19] op_sel:[0,0,1] op_sel_hi:[1,0,1]
    v_pk_fma_f32 v[108:109], v[20:21], s[20:21], s[20:21] op_sel:[0,0,1] op_sel_hi:[1,0,1]
    v_pk_fma_f32 v[110:111], v[22:23], s[22:23], s[22:23] op_sel:[0,0,1] op_sel_hi:[1,0,1]
    v_pk_fma_f32 v[112:113], v[24:25], s[24:25], s[24:25] op_sel:[0,0,1] op_sel_hi:[1,0,1]
    v_pk_fma_f32 v[114:115], v[26:27], s[26:27], s[26:27] op_sel:[0,0,1] op_sel_hi:[1,0,1]
    v_pk_fma_f32 v[116:117], v[28:29], s[28:29], s[28:29] op_sel:[0,0,1] op_sel_hi:[1,0,1]
    v_pk_fma_f32 v[118:119], v[30:31], s[30:31], s[30:31] op_sel:[0,0,1] op_sel_hi:[1,0,1]
    v_cvt_pk_bf16_f32 v88, v104, v112
    v_cvt_pk_bf16_f32 v89, v106, v114
    v_cvt_pk_bf16_f32 v90, v108, v116
    v_cvt_pk_bf16_f32 v91, v110, v118
    buffer_store_dwordx4 v[88:91], v1, s[12:15], s73 offen sc1
    v_cvt_pk_bf16_f32 v92, v105, v113
    v_cvt_pk_bf16_f32 v93, v107, v115
    v_cvt_pk_bf16_f32 v94, v109, v117
    v_cvt_pk_bf16_f32 v95, v111, v119
    buffer_store_dwordx4 v[92:95], v11, s[12:15], s73 offen sc1
    s_add_u32 s72, s72, 4194304
    v_pk_fma_f32 v[48:49], v[104:105], v[128:129], v[16:17]
    v_pk_fma_f32 v[50:51], v[106:107], v[128:129], v[18:19]
    v_pk_fma_f32 v[52:53], v[108:109], v[128:129], v[20:21]
    v_pk_fma_f32 v[54:55], v[110:111], v[128:129], v[22:23]
    v_pk_fma_f32 v[56:57], v[112:113], v[128:129], v[24:25]
    v_pk_fma_f32 v[58:59], v[114:115], v[128:129], v[26:27]
    v_pk_fma_f32 v[60:61], v[116:117], v[128:129], v[28:29]
    v_pk_fma_f32 v[62:63], v[118:119], v[128:129], v[30:31]
    s_cmp_lg_u32 s6, 0
    s_cbranch_scc1 L_conv
    s_call_b64 s[60:61], L_kg2
    s_call_b64 s[60:61], L_kfrag
    s_waitcnt vmcnt(0)
    v_mov_b32 v12, -1
    v_mov_b32 v13, -1
    v_mov_b32 v14, -1
    v_mov_b32 v15, -1
    s_add_u32 s82, s79, 8388608
    buffer_store_dwordx4 v[12:15], v1, s[12:15], s82 offen sc1
    buffer_store_dwordx4 v[12:15], v11, s[12:15], s82 offen sc1
L_conv:
    s_waitcnt vmcnt(2)
L_c_chk_13:
    s_nop 0
    v_max3_u32 v12, v144, v145, v146
    v_max_u32 v12, v12, v147
    v_cmp_eq_u32 vcc, -1, v12
    s_nop 0
    s_cbranch_vccnz L_c_rt_14
L_c_ok_15:
    ds_write2st64_b32 v4, v144, v145 offset0:0 offset1:5
    ds_write2st64_b32 v4, v146, v147 offset0:10 offset1:15
    ds_write2st64_b32 v130, v144, v145 offset0:0 offset1:5
    ds_write2st64_b32 v130, v146, v147 offset0:10 offset1:15
    s_add_u32 s74, s74, 1048576
    s_cmp_lg_u32 s77, 0
    s_waitcnt lgkmcnt(0)
    s_barrier
    s_cbranch_scc1 L_p1B_1
L_p1B_0:
    s_nop 0
    ds_read_b128 v[164:167], v5 offset:0
    ds_read_b128 v[168:171], v5 offset:1280
    ds_read_b128 v[172:175], v5 offset:2560
    ds_read_b128 v[176:179], v5 offset:3840
    ds_read_b128 v[180:183], v5 offset:64
    ds_read_b128 v[184:187], v5 offset:1344
    s_waitcnt lgkmcnt(5)
    v_mfma_f32_16x16x32_bf16 v[152:155], a[28:31], v[164:167], 0
    ds_read_b128 v[188:191], v5 offset:2624
    v_mfma_f32_16x16x32_bf16 v[148:151], a[4:7], v[164:167], 0
    s_waitcnt lgkmcnt(5)
    v_mfma_f32_16x16x32_bf16 v[152:155], a[92:95], v[168:171], v[152:155]
    ds_read_b128 v[192:195], v5 offset:3904
    v_mfma_f32_16x16x32_bf16 v[148:151], a[68:71], v[168:171], v[148:151]
    s_waitcnt lgkmcnt(4)
    v_mfma_f32_16x16x32_bf16 v[152:155], a[156:159], v[172:175], v[152:155]
    ds_read_b128 v[196:199], v5 offset:128
    v_mfma_f32_16x16x32_bf16 v[148:151], a[132:135], v[172:175], v[148:151]
    v_mfma_f32_16x16x32_bf16 v[152:155], a[220:223], v[176:179], v[152:155]
    ds_read_b128 v[164:167], v5 offset:1408
    v_mfma_f32_16x16x32_bf16 v[148:151], a[196:199], v[176:179], v[148:151]
    s_waitcnt lgkmcnt(4)
    v_mfma_f32_16x16x32_bf16 v[152:155], a[24:27], v[180:183], v[152:155]
    ds_read_b128 v[168:171], v5 offset:2688
    v_mfma_f32_16x16x32_bf16 v[148:151], a[0:3], v[180:183], v[148:151]
    v_mfma_f32_16x16x32_bf16 v[152:155], a[88:91], v[184:187], v[152:155]
    ds_read_b128 v[172:175], v5 offset:3968
    v_mfma_f32_16x16x32_bf16 v[148:151], a[64:67], v[184:187], v[148:151]
    s_waitcnt lgkmcnt(4)
    v_mfma_f32_16x16x32_bf16 v[152:155], a[152:155], v[188:191], v[152:155]
    ds_read_b128 v[176:179], v5 offset:192
    v_mfma_f32_16x16x32_bf16 v[148:151], a[128:131], v[188:191], v[148:151]
    v_mfma_f32_16x16x32_bf16 v[152:155], a[216:219], v[192:195], v[152:155]
    ds_read_b128 v[180:183], v5 offset:1472
    v_mfma_f32_16x16x32_bf16 v[148:151], a[192:195], v[192:195], v[148:151]
    s_waitcnt lgkmcnt(4)
    v_mfma_f32_16x16x32_bf16 v[152:155], a[20:23], v[196:199], v[152:155]
    ds_read_b128 v[184:187], v5 offset:2752
    v_mfma_f32_16x16x32_bf16 v[152:155], a[84:87], v[164:167], v[152:155]
    ds_read_b128 v[188:191], v5 offset:4032
    s_waitcnt lgkmcnt(4)
    v_mfma_f32_16x16x32_bf16 v[152:155], a[148:151], v[168:171], v[152:155]
    ds_read_b128 v[192:195], v5 offset:256
    v_mfma_f32_16x16x32_bf16 v[152:155], a[212:215], v[172:175], v[152:155]
    ds_read_b128 v[196:199], v5 offset:1536
    s_waitcnt lgkmcnt(4)
    v_mfma_f32_16x16x32_bf16 v[152:155], a[16:19], v[176:179], v[152:155]
    ds_read_b128 v[164:167], v5 offset:2816
    v_mfma_f32_16x16x32_bf16 v[152:155], a[80:83], v[180:183], v[152:155]
    ds_read_b128 v[168:171], v5 offset:4096
    s_waitcnt lgkmcnt(4)
    v_mfma_f32_16x16x32_bf16 v[152:155], a[144:147], v[184:187], v[152:155]
    ds_read_b128 v[172:175], v5 offset:320
    v_mfma_f32_16x16x32_bf16 v[152:155], a[208:211], v[188:191], v[152:155]
    ds_read_b128 v[176:179], v5 offset:1600
    s_waitcnt lgkmcnt(4)
    v_mfma_f32_16x16x32_bf16 v[152:155], a[12:15], v[192:195], v[152:155]
    ds_read_b128 v[180:183], v5 offset:2880
    v_mfma_f32_16x16x32_bf16 v[152:155], a[76:79], v[196:199], v[152:155]
    ds_read_b128 v[184:187], v5 offset:4160
    s_waitcnt lgkmcnt(4)
    v_mfma_f32_16x16x32_bf16 v[152:155], a[140:143], v[164:167], v[152:155]
    ds_read_b128 v[188:191], v5 offset:384
    v_mfma_f32_16x16x32_bf16 v[152:155], a[204:207], v[168:171], v[152:155]
    ds_read_b128 v[192:195], v5 offset:1664
    s_waitcnt lgkmcnt(4)
    v_mfma_f32_16x16x32_bf16 v[152:155], a[8:11], v[172:175], v[152:155]
    ds_read_b128 v[196:199], v5 offset:2944
    v_mfma_f32_16x16x32_bf16 v[152:155], a[72:75], v[176:179], v[152:155]
    ds_read_b128 v[164:167], v5 offset:4224
    s_waitcnt lgkmcnt(4)
    v_mfma_f32_16x16x32_bf16 v[152:155], a[136:139], v[180:183], v[152:155]
    ds_read_b128 v[168:171], v5 offset:448
    v_mfma_f32_16x16x32_bf16 v[152:155], a[200:203], v[184:187], v[152:155]
    ds_read_b128 v[172:175], v5 offset:1728
    s_waitcnt lgkmcnt(4)
    v_mfma_f32_16x16x32_bf16 v[152:155], a[4:7], v[188:191], v[152:155]
    ds_read_b128 v[176:179], v5 offset:3008
    v_mfma_f32_16x16x32_bf16 v[152:155], a[68:71], v[192:195], v[152:155]
    ds_read_b128 v[180:183], v5 offset:4288
    s_waitcnt lgkmcnt(4)
    v_mfma_f32_16x16x32_bf16 v[152:155], a[132:135], v[196:199], v[152:155]
    ds_read_b128 v[184:187], v5 offset:448
    v_cvt_pk_bf16_f32 v156, v148, v149
    v_mfma_f32_16x16x32_bf16 v[152:155], a[196:199], v[164:167], v[152:155]
    ds_read_b128 v[188:191], v5 offset:1728
    v_cvt_pk_bf16_f32 v157, v150, v151
    s_waitcnt lgkmcnt(4)
    v_mfma_f32_16x16x32_bf16 v[152:155], a[0:3], v[168:171], v[152:155]
    ds_read_b128 v[192:195], v5 offset:3008
    ds_write_b64 v7, v[156:157] offset:0
    v_mfma_f32_16x16x32_bf16 v[152:155], a[64:67], v[172:175], v[152:155]
    ds_read_b128 v[196:199], v5 offset:4288
    s_waitcnt lgkmcnt(5)
    v_mfma_f32_16x16x32_bf16 v[152:155], a[128:131], v[176:179], v[152:155]
    ds_read_b128 v[164:167], v5 offset:384
    v_mfma_f32_16x16x32_bf16 v[152:155], a[192:195], v[180:183], v[152:155]
    ds_read_b128 v[168:171], v5 offset:1664
    s_waitcnt lgkmcnt(5)
    v_mfma_f32_16x16x32_bf16 v[200:203], a[8:11], v[184:187], 0
    ds_read_b128 v[172:175], v5 offset:2944
    ds_read_b64_tr_b16 a[40:41], v6 offset:2592
    v_mfma_f32_16x16x32_bf16 v[204:207], a[32:35], v[184:187], 0
    ds_read_b64_tr_b16 a[42:43], v6 offset:2560
    v_mfma_f32_16x16x32_bf16 v[200:203], a[72:75], v[188:191], v[200:203]
    ds_read_b128 v[176:179], v5 offset:4224
    ds_read_b64_tr_b16 a[104:105], v6 offset:6752
    v_cvt_pk_bf16_f32 v158, v152, v153
    v_mfma_f32_16x16x32_bf16 v[204:207], a[96:99], v[188:191], v[204:207]
    ds_read_b64_tr_b16 a[106:107], v6 offset:6720
    v_cvt_pk_bf16_f32 v159, v154, v155
    s_waitcnt lgkmcnt(8)
    v_mfma_f32_16x16x32_bf16 v[200:203], a[136:139], v[192:195], v[200:203]
    ds_read_b128 v[180:183], v5 offset:320
    ds_read_b64_tr_b16 a[168:169], v6 offset:10912
    ds_write_b64 v7, v[158:159] offset:3840
    v_mfma_f32_16x16x32_bf16 v[204:207], a[160:163], v[192:195], v[204:207]
    ds_read_b64_tr_b16 a[170:171], v6 offset:10880
    v_mfma_f32_16x16x32_bf16 v[200:203], a[200:203], v[196:199], v[200:203]
    ds_read_b128 v[184:187], v5 offset:1600
    ds_read_b64_tr_b16 a[232:233], v6 offset:15072
    v_mfma_f32_16x16x32_bf16 v[204:207], a[224:227], v[196:199], v[204:207]
    ds_read_b64_tr_b16 a[234:235], v6 offset:15040
    s_waitcnt lgkmcnt(13)
    v_mfma_f32_16x16x32_bf16 v[200:203], a[12:15], v[164:167], v[200:203]
    ds_read_b128 v[188:191], v5 offset:2880
    ds_read_b64_tr_b16 a[44:45], v6 offset:2848
    s_waitcnt vmcnt(0)
    s_waitcnt lgkmcnt(6)
    s_barrier
    v_mfma_f32_16x16x32_bf16 v[204:207], a[36:39], v[164:167], v[204:207]
    ds_read_b64_tr_b16 a[46:47], v6 offset:2816
    ds_read_b128 v[160:163], v8
    v_mfma_f32_16x16x32_bf16 v[200:203], a[76:79], v[168:171], v[200:203]
    ds_read_b128 v[192:195], v5 offset:4160
    ds_read_b64_tr_b16 a[108:109], v6 offset:7008
    v_mfma_f32_16x16x32_bf16 v[204:207], a[100:103], v[168:171], v[204:207]
    ds_read_b64_tr_b16 a[110:111], v6 offset:6976
    buffer_load_dwordx4 v[144:147], v2, s[12:15], s74 offen sc1
    v_mfma_f32_16x16x32_bf16 v[200:203], a[140:143], v[172:175], v[200:203]
    ds_read_b128 v[196:199], v5 offset:256
    ds_read_b64_tr_b16 a[172:173], v6 offset:11168
    v_mfma_f32_16x16x32_bf16 v[204:207], a[164:167], v[172:175], v[204:207]
    ds_read_b64_tr_b16 a[174:175], v6 offset:11136
    s_waitcnt lgkmcnt(6)
    buffer_store_dwordx4 v[160:163], v1, s[12:15], s75 offen sc1
    v_mfma_f32_16x16x32_bf16 v[200:203], a[204:207], v[176:179], v[200:203]
    ds_read_b128 v[164:167], v5 offset:1536
    ds_read_b64_tr_b16 a[236:237], v6 offset:15328
    v_mfma_f32_16x16x32_bf16 v[204:207], a[228:231], v[176:179], v[204:207]
    ds_read_b64_tr_b16 a[238:239], v6 offset:15296
    v_mfma_f32_16x16x32_bf16 v[200:203], a[16:19], v[180:183], v[200:203]
    ds_read_b128 v[168:171], v5 offset:2816
    ds_read_b64_tr_b16 a[48:49], v6 offset:3104
    v_mfma_f32_16x16x32_bf16 v[204:207], a[40:43], v[180:183], v[204:207]
    ds_read_b64_tr_b16 a[50:51], v6 offset:3072
    v_mfma_f32_16x16x32_bf16 v[200:203], a[80:83], v[184:187], v[200:203]
    ds_read_b128 v[172:175], v5 offset:4096
    ds_read_b64_tr_b16 a[112:113], v6 offset:7264
    v_mfma_f32_16x16x32_bf16 v[204:207], a[104:107], v[184:187], v[204:207]
    ds_read_b64_tr_b16 a[114:115], v6 offset:7232
    s_waitcnt lgkmcnt(14)
    v_mfma_f32_16x16x32_bf16 v[200:203], a[144:147], v[188:191], v[200:203]
    ds_read_b128 v[176:179], v5 offset:192
    ds_read_b64_tr_b16 a[176:177], v6 offset:11424
    v_mfma_f32_16x16x32_bf16 v[204:207], a[168:171], v[188:191], v[204:207]
    ds_read_b64_tr_b16 a[178:179], v6 offset:11392
    v_mfma_f32_16x16x32_bf16 v[200:203], a[208:211], v[192:195], v[200:203]
    ds_read_b128 v[180:183], v5 offset:1472
    ds_read_b64_tr_b16 a[240:241], v6 offset:15584
    v_mfma_f32_16x16x32_bf16 v[204:207], a[232:235], v[192:195], v[204:207]
    ds_read_b64_tr_b16 a[242:243], v6 offset:15552
    s_waitcnt lgkmcnt(14)
    v_mfma_f32_16x16x32_bf16 v[200:203], a[20:23], v[196:199], v[200:203]
    ds_read_b128 v[184:187], v5 offset:2752
    ds_read_b64_tr_b16 a[52:53], v6 offset:3360
    v_mfma_f32_16x16x32_bf16 v[204:207], a[44:47], v[196:199], v[204:207]
    ds_read_b64_tr_b16 a[54:55], v6 offset:3328
    v_mfma_f32_16x16x32_bf16 v[200:203], a[84:87], v[164:167], v[200:203]
    ds_read_b128 v[188:191], v5 offset:4032
    ds_read_b64_tr_b16 a[116:117], v6 offset:7520
    v_mfma_f32_16x16x32_bf16 v[204:207], a[108:111], v[164:167], v[204:207]
    ds_read_b64_tr_b16 a[118:119], v6 offset:7488
    s_waitcnt lgkmcnt(14)
    v_mfma_f32_16x16x32_bf16 v[200:203], a[148:151], v[168:171], v[200:203]
    ds_read_b128 v[192:195], v5 offset:128
    ds_read_b64_tr_b16 a[180:181], v6 offset:11680
    v_mfma_f32_16x16x32_bf16 v[204:207], a[172:175], v[168:171], v[204:207]
    ds_read_b64_tr_b16 a[182:183], v6 offset:11648
    v_mfma_f32_16x16x32_bf16 v[200:203], a[212:215], v[172:175], v[200:203]
    ds_read_b128 v[196:199], v5 offset:1408
    ds_read_b64_tr_b16 a[244:245], v6 offset:15840
    v_mfma_f32_16x16x32_bf16 v[204:207], a[236:239], v[172:175], v[204:207]
    ds_read_b64_tr_b16 a[246:247], v6 offset:15808
    s_waitcnt lgkmcnt(14)
    v_mfma_f32_16x16x32_bf16 v[200:203], a[24:27], v[176:179], v[200:203]
    ds_read_b128 v[164:167], v5 offset:2688
    ds_read_b64_tr_b16 a[56:57], v6 offset:3616
    v_mfma_f32_16x16x32_bf16 v[204:207], a[48:51], v[176:179], v[204:207]
    ds_read_b64_tr_b16 a[58:59], v6 offset:3584
    v_mfma_f32_16x16x32_bf16 v[200:203], a[88:91], v[180:183], v[200:203]
    ds_read_b128 v[168:171], v5 offset:3968
    ds_read_b64_tr_b16 a[120:121], v6 offset:7776
    v_mfma_f32_16x16x32_bf16 v[204:207], a[112:115], v[180:183], v[204:207]
    ds_read_b64_tr_b16 a[122:123], v6 offset:7744
    s_waitcnt lgkmcnt(14)
    v_mfma_f32_16x16x32_bf16 v[200:203], a[152:155], v[184:187], v[200:203]
    ds_read_b128 v[172:175], v5 offset:64
    ds_read_b64_tr_b16 a[184:185], v6 offset:11936
    v_mfma_f32_16x16x32_bf16 v[204:207], a[176:179], v[184:187], v[204:207]
    ds_read_b64_tr_b16 a[186:187], v6 offset:11904
    v_mfma_f32_16x16x32_bf16 v[200:203], a[216:219], v[188:191], v[200:203]
    ds_read_b128 v[176:179], v5 offset:1344
    ds_read_b64_tr_b16 a[248:249], v6 offset:16096
    v_mfma_f32_16x16x32_bf16 v[204:207], a[240:243], v[188:191], v[204:207]
    ds_read_b64_tr_b16 a[250:251], v6 offset:16064
    s_waitcnt lgkmcnt(14)
    v_mfma_f32_16x16x32_bf16 v[200:203], a[28:31], v[192:195], v[200:203]
    ds_read_b128 v[180:183], v5 offset:2624
    ds_read_b64_tr_b16 a[60:61], v6 offset:3872
    v_mfma_f32_16x16x32_bf16 v[204:207], a[52:55], v[192:195], v[204:207]
    ds_read_b64_tr_b16 a[62:63], v6 offset:3840
    v_mfma_f32_16x16x32_bf16 v[200:203], a[92:95], v[196:199], v[200:203]
    ds_read_b128 v[184:187], v5 offset:3904
    ds_read_b64_tr_b16 a[124:125], v6 offset:8032
    v_mfma_f32_16x16x32_bf16 v[204:207], a[116:119], v[196:199], v[204:207]
    ds_read_b64_tr_b16 a[126:127], v6 offset:8000
    s_waitcnt lgkmcnt(14)
    v_mfma_f32_16x16x32_bf16 v[200:203], a[156:159], v[164:167], v[200:203]
    ds_read_b128 v[188:191], v5 offset:0
    ds_read_b64_tr_b16 a[188:189], v6 offset:12192
    v_mfma_f32_16x16x32_bf16 v[204:207], a[180:183], v[164:167], v[204:207]
    ds_read_b64_tr_b16 a[190:191], v6 offset:12160
    v_mfma_f32_16x16x32_bf16 v[200:203], a[220:223], v[168:171], v[200:203]
    ds_read_b128 v[192:195], v5 offset:1280
    ds_read_b64_tr_b16 a[252:253], v6 offset:16352
    v_mfma_f32_16x16x32_bf16 v[204:207], a[244:247], v[168:171], v[204:207]
    ds_read_b64_tr_b16 a[254:255], v6 offset:16320
    s_waitcnt lgkmcnt(14)
    v_mfma_f32_16x16x32_bf16 v[200:203], a[32:35], v[172:175], v[200:203]
    ds_read_b128 v[196:199], v5 offset:2560
    v_mfma_f32_16x16x32_bf16 v[204:207], a[56:59], v[172:175], v[204:207]
    v_mfma_f32_16x16x32_bf16 v[200:203], a[96:99], v[176:179], v[200:203]
    ds_read_b128 v[164:167], v5 offset:3840
    v_mfma_f32_16x16x32_bf16 v[204:207], a[120:123], v[176:179], v[204:207]
    s_waitcnt vmcnt(1)
    v_max3_u32 v12, v144, v145, v146
    s_waitcnt lgkmcnt(10)
    v_mfma_f32_16x16x32_bf16 v[200:203], a[160:163], v[180:183], v[200:203]
    v_max_u32 v12, v12, v147
    v_cmp_eq_u32 vcc, -1, v12
    v_mfma_f32_16x16x32_bf16 v[204:207], a[184:187], v[180:183], v[204:207]
    s_cbranch_vccnz L_h0_rt_16
L_h0_ok_17:
    v_mfma_f32_16x16x32_bf16 v[200:203], a[224:227], v[184:187], v[200:203]
    ds_write2st64_b32 v4, v144, v145 offset0:2 offset1:7
    v_mfma_f32_16x16x32_bf16 v[204:207], a[248:251], v[184:187], v[204:207]
    ds_write2st64_b32 v4, v146, v147 offset0:12 offset1:17
    s_waitcnt lgkmcnt(6)
    v_mfma_f32_16x16x32_bf16 v[200:203], a[36:39], v[188:191], v[200:203]
    ds_write2st64_b32 v130, v144, v145 offset0:2 offset1:7
    v_mfma_f32_16x16x32_bf16 v[204:207], a[60:63], v[188:191], v[204:207]
    ds_write2st64_b32 v130, v146, v147 offset0:12 offset1:17
    v_mfma_f32_16x16x32_bf16 v[200:203], a[100:103], v[192:195], v[200:203]
    v_mfma_f32_16x16x32_bf16 v[204:207], a[124:127], v[192:195], v[204:207]
    s_waitcnt lgkmcnt(4)
    v_mfma_f32_16x16x32_bf16 v[200:203], a[164:167], v[196:199], v[200:203]
    s_waitcnt lgkmcnt(0)
    s_barrier
    v_mfma_f32_16x16x32_bf16 v[204:207], a[188:191], v[196:199], v[204:207]
    ds_read_b128 v[168:171], v5 offset:512
    v_mfma_f32_16x16x32_bf16 v[200:203], a[228:231], v[164:167], v[200:203]
    ds_read_b128 v[172:175], v5 offset:1792
    v_mfma_f32_16x16x32_bf16 v[204:207], a[252:255], v[164:167], v[204:207]
    ds_read_b128 v[176:179], v5 offset:3072
    s_waitcnt lgkmcnt(1)
    v_mfma_f32_16x16x32_bf16 v[204:207], a[28:31], v[168:171], v[204:207]
    ds_read_b128 v[180:183], v5 offset:4352
    v_mfma_f32_16x16x32_bf16 v[200:203], a[4:7], v[168:171], v[200:203]
    ds_read_b128 v[184:187], v5 offset:576
    v_mfma_f32_16x16x32_bf16 v[204:207], a[92:95], v[172:175], v[204:207]
    ds_read_b128 v[188:191], v5 offset:1856
    v_mfma_f32_16x16x32_bf16 v[200:203], a[68:71], v[172:175], v[200:203]
    ds_read_b128 v[192:195], v5 offset:3136
    s_waitcnt lgkmcnt(3)
    v_mfma_f32_16x16x32_bf16 v[204:207], a[156:159], v[176:179], v[204:207]
    ds_read_b128 v[196:199], v5 offset:4416
    v_mfma_f32_16x16x32_bf16 v[200:203], a[132:135], v[176:179], v[200:203]
    ds_read_b128 v[164:167], v5 offset:640
    v_mfma_f32_16x16x32_bf16 v[204:207], a[220:223], v[180:183], v[204:207]
    ds_read_b128 v[168:171], v5 offset:1920
    v_mfma_f32_16x16x32_bf16 v[200:203], a[196:199], v[180:183], v[200:203]
    s_waitcnt lgkmcnt(4)
    v_mfma_f32_16x16x32_bf16 v[204:207], a[24:27], v[184:187], v[204:207]
    ds_read_b128 v[172:175], v5 offset:3200
    v_mfma_f32_16x16x32_bf16 v[200:203], a[0:3], v[184:187], v[200:203]
    v_mfma_f32_16x16x32_bf16 v[204:207], a[88:91], v[188:191], v[204:207]
    ds_read_b128 v[176:179], v5 offset:4480
    v_mfma_f32_16x16x32_bf16 v[200:203], a[64:67], v[188:191], v[200:203]
    s_waitcnt lgkmcnt(4)
    v_mfma_f32_16x16x32_bf16 v[204:207], a[152:155], v[192:195], v[204:207]
    ds_read_b128 v[180:183], v5 offset:704
    v_mfma_f32_16x16x32_bf16 v[200:203], a[128:131], v[192:195], v[200:203]
    v_mfma_f32_16x16x32_bf16 v[204:207], a[216:219], v[196:199], v[204:207]
    ds_read_b128 v[184:187], v5 offset:1984
    v_mfma_f32_16x16x32_bf16 v[200:203], a[192:195], v[196:199], v[200:203]
    s_mov_b64 exec, s[92:93]
    buffer_load_dwordx4 v[120:123], v2, s[12:15], s72 offen sc1
    buffer_load_dwordx4 v[124:127], v3, s[12:15], s72 offen sc1
    s_mov_b64 exec, -1
    s_waitcnt lgkmcnt(4)
    v_mfma_f32_16x16x32_bf16 v[204:207], a[20:23], v[164:167], v[204:207]
    ds_read_b128 v[188:191], v5 offset:3264
    v_mfma_f32_16x16x32_bf16 v[204:207], a[84:87], v[168:171], v[204:207]
    ds_read_b128 v[192:195], v5 offset:4544
    s_waitcnt lgkmcnt(4)
    v_mfma_f32_16x16x32_bf16 v[204:207], a[148:151], v[172:175], v[204:207]
    ds_read_b128 v[196:199], v5 offset:768
    v_mfma_f32_16x16x32_bf16 v[204:207], a[212:215], v[176:179], v[204:207]
    ds_read_b128 v[164:167], v5 offset:2048
    s_waitcnt lgkmcnt(4)
    v_mfma_f32_16x16x32_bf16 v[204:207], a[16:19], v[180:183], v[204:207]
    ds_read_b128 v[168:171], v5 offset:3328
    v_mfma_f32_16x16x32_bf16 v[204:207], a[80:83], v[184:187], v[204:207]
    ds_read_b128 v[172:175], v5 offset:4608
    s_waitcnt lgkmcnt(4)
    v_mfma_f32_16x16x32_bf16 v[204:207], a[144:147], v[188:191], v[204:207]
    ds_read_b128 v[176:179], v5 offset:832
    v_mfma_f32_16x16x32_bf16 v[204:207], a[208:211], v[192:195], v[204:207]
    ds_read_b128 v[180:183], v5 offset:2112
    s_waitcnt lgkmcnt(4)
    v_mfma_f32_16x16x32_bf16 v[204:207], a[12:15], v[196:199], v[204:207]
    ds_read_b128 v[184:187], v5 offset:3392
    v_mfma_f32_16x16x32_bf16 v[204:207], a[76:79], v[164:167], v[204:207]
    ds_read_b128 v[188:191], v5 offset:4672
    s_waitcnt lgkmcnt(4)
    v_mfma_f32_16x16x32_bf16 v[204:207], a[140:143], v[168:171], v[204:207]
    ds_read_b128 v[192:195], v5 offset:896
    v_mfma_f32_16x16x32_bf16 v[204:207], a[204:207], v[172:175], v[204:207]
    ds_read_b128 v[196:199], v5 offset:2176
    s_waitcnt lgkmcnt(4)
    v_mfma_f32_16x16x32_bf16 v[204:207], a[8:11], v[176:179], v[204:207]
    ds_read_b128 v[164:167], v5 offset:3456
    v_mfma_f32_16x16x32_bf16 v[204:207], a[72:75], v[180:183], v[204:207]
    ds_read_b128 v[168:171], v5 offset:4736
    s_waitcnt lgkmcnt(4)
    v_mfma_f32_16x16x32_bf16 v[204:207], a[136:139], v[184:187], v[204:207]
    ds_read_b128 v[172:175], v5 offset:960
    v_mfma_f32_16x16x32_bf16 v[204:207], a[200:203], v[188:191], v[204:207]
    ds_read_b128 v[176:179], v5 offset:2240
    s_waitcnt lgkmcnt(4)
    v_mfma_f32_16x16x32_bf16 v[204:207], a[4:7], v[192:195], v[204:207]
    ds_read_b128 v[180:183], v5 offset:3520
    v_mfma_f32_16x16x32_bf16 v[204:207], a[68:71], v[196:199], v[204:207]
    ds_read_b128 v[184:187], v5 offset:4800
    s_waitcnt lgkmcnt(4)
    v_mfma_f32_16x16x32_bf16 v[204:207], a[132:135], v[164:167], v[204:207]
    v_cvt_pk_bf16_f32 v156, v200, v201
    v_mfma_f32_16x16x32_bf16 v[204:207], a[196:199], v[168:171], v[204:207]
    v_cvt_pk_bf16_f32 v157, v202, v203
    s_waitcnt lgkmcnt(2)
    v_mfma_f32_16x16x32_bf16 v[204:207], a[0:3], v[172:175], v[204:207]
    ds_write_b64 v7, v[156:157] offset:5120
    v_mfma_f32_16x16x32_bf16 v[204:207], a[64:67], v[176:179], v[204:207]
    s_waitcnt lgkmcnt(1)
    v_mfma_f32_16x16x32_bf16 v[204:207], a[128:131], v[180:183], v[204:207]
    v_mfma_f32_16x16x32_bf16 v[204:207], a[192:195], v[184:187], v[204:207]
    s_lshl_b32 s57, s84, 22
    s_add_u32 s73, s57, s79
    s_add_u32 s73, s73, 4194304
    s_add_u32 s74, s57, s80
    s_add_u32 s74, s74, 4194304
    s_add_u32 s75, s75, 4096
    s_nop 1
    v_cvt_pk_bf16_f32 v158, v204, v205
    v_cvt_pk_bf16_f32 v159, v206, v207
    ds_write_b64 v7, v[158:159] offset:8960
    s_branch L_ctailB
L_p1B_1:
    ds_read_b128 v[164:167], v5 offset:0
    ds_read_b128 v[168:171], v5 offset:1280
    ds_read_b128 v[172:175], v5 offset:2560
    ds_read_b128 v[176:179], v5 offset:3840
    ds_read_b128 v[180:183], v5 offset:64
    ds_read_b128 v[184:187], v5 offset:1344
    s_waitcnt lgkmcnt(5)
    v_mfma_f32_16x16x32_bf16 v[152:155], a[20:23], v[164:167], 0
    ds_read_b128 v[188:191], v5 offset:2624
    v_mfma_f32_16x16x32_bf16 v[148:151], a[12:15], v[164:167], 0
    s_waitcnt lgkmcnt(5)
    v_mfma_f32_16x16x32_bf16 v[152:155], a[84:87], v[168:171], v[152:155]
    ds_read_b128 v[192:195], v5 offset:3904
    v_mfma_f32_16x16x32_bf16 v[148:151], a[76:79], v[168:171], v[148:151]
    s_waitcnt lgkmcnt(4)
    v_mfma_f32_16x16x32_bf16 v[152:155], a[148:151], v[172:175], v[152:155]
    ds_read_b128 v[196:199], v5 offset:128
    v_mfma_f32_16x16x32_bf16 v[148:151], a[140:143], v[172:175], v[148:151]
    v_mfma_f32_16x16x32_bf16 v[152:155], a[212:215], v[176:179], v[152:155]
    ds_read_b128 v[164:167], v5 offset:1408
    v_mfma_f32_16x16x32_bf16 v[148:151], a[204:207], v[176:179], v[148:151]
    s_waitcnt lgkmcnt(4)
    v_mfma_f32_16x16x32_bf16 v[152:155], a[16:19], v[180:183], v[152:155]
    ds_read_b128 v[168:171], v5 offset:2688
    v_mfma_f32_16x16x32_bf16 v[148:151], a[8:11], v[180:183], v[148:151]
    v_mfma_f32_16x16x32_bf16 v[152:155], a[80:83], v[184:187], v[152:155]
    ds_read_b128 v[172:175], v5 offset:3968
    v_mfma_f32_16x16x32_bf16 v[148:151], a[72:75], v[184:187], v[148:151]
    s_waitcnt lgkmcnt(4)
    v_mfma_f32_16x16x32_bf16 v[152:155], a[144:147], v[188:191], v[152:155]
    ds_read_b128 v[176:179], v5 offset:192
    v_mfma_f32_16x16x32_bf16 v[148:151], a[136:139], v[188:191], v[148:151]
    v_mfma_f32_16x16x32_bf16 v[152:155], a[208:211], v[192:195], v[152:155]
    ds_read_b128 v[180:183], v5 offset:1472
    v_mfma_f32_16x16x32_bf16 v[148:151], a[200:203], v[192:195], v[148:151]
    s_waitcnt lgkmcnt(4)
    v_mfma_f32_16x16x32_bf16 v[152:155], a[12:15], v[196:199], v[152:155]
    ds_read_b128 v[184:187], v5 offset:2752
    v_mfma_f32_16x16x32_bf16 v[148:151], a[4:7], v[196:199], v[148:151]
    v_mfma_f32_16x16x32_bf16 v[152:155], a[76:79], v[164:167], v[152:155]
    ds_read_b128 v[188:191], v5 offset:4032
    v_mfma_f32_16x16x32_bf16 v[148:151], a[68:71], v[164:167], v[148:151]
    s_waitcnt lgkmcnt(4)
    v_mfma_f32_16x16x32_bf16 v[152:155], a[140:143], v[168:171], v[152:155]
    ds_read_b128 v[192:195], v5 offset:256
    v_mfma_f32_16x16x32_bf16 v[148:151], a[132:135], v[168:171], v[148:151]
    v_mfma_f32_16x16x32_bf16 v[152:155], a[204:207], v[172:175], v[152:155]
    ds_read_b128 v[196:199], v5 offset:1536
    v_mfma_f32_16x16x32_bf16 v[148:151], a[196:199], v[172:175], v[148:151]
    s_waitcnt lgkmcnt(4)
    v_mfma_f32_16x16x32_bf16 v[152:155], a[8:11], v[176:179], v[152:155]
    ds_read_b128 v[164:167], v5 offset:2816
    v_mfma_f32_16x16x32_bf16 v[148:151], a[0:3], v[176:179], v[148:151]
    v_mfma_f32_16x16x32_bf16 v[152:155], a[72:75], v[180:183], v[152:155]
    ds_read_b128 v[168:171], v5 offset:4096
    v_mfma_f32_16x16x32_bf16 v[148:151], a[64:67], v[180:183], v[148:151]
    s_waitcnt lgkmcnt(4)
    v_mfma_f32_16x16x32_bf16 v[152:155], a[136:139], v[184:187], v[152:155]
    ds_read_b128 v[172:175], v5 offset:320
    v_mfma_f32_16x16x32_bf16 v[148:151], a[128:131], v[184:187], v[148:151]
    v_mfma_f32_16x16x32_bf16 v[152:155], a[200:203], v[188:191], v[152:155]
    ds_read_b128 v[176:179], v5 offset:1600
    v_mfma_f32_16x16x32_bf16 v[148:151], a[192:195], v[188:191], v[148:151]
    s_waitcnt lgkmcnt(4)
    v_mfma_f32_16x16x32_bf16 v[152:155], a[4:7], v[192:195], v[152:155]
    ds_read_b128 v[180:183], v5 offset:2880
    v_mfma_f32_16x16x32_bf16 v[152:155], a[68:71], v[196:199], v[152:155]
    ds_read_b128 v[184:187], v5 offset:4160
    s_waitcnt lgkmcnt(4)
    v_mfma_f32_16x16x32_bf16 v[152:155], a[132:135], v[164:167], v[152:155]
    ds_read_b128 v[188:191], v5 offset:448
    v_cvt_pk_bf16_f32 v156, v148, v149
    v_mfma_f32_16x16x32_bf16 v[152:155], a[196:199], v[168:171], v[152:155]
    ds_read_b128 v[192:195], v5 offset:1728
    v_cvt_pk_bf16_f32 v157, v150, v151
    s_waitcnt lgkmcnt(4)
    v_mfma_f32_16x16x32_bf16 v[152:155], a[0:3], v[172:175], v[152:155]
    ds_read_b128 v[196:199], v5 offset:3008
    ds_write_b64 v7, v[156:157] offset:0
    v_mfma_f32_16x16x32_bf16 v[152:155], a[64:67], v[176:179], v[152:155]
    ds_read_b128 v[164:167], v5 offset:4288
    s_waitcnt lgkmcnt(5)
    v_mfma_f32_16x16x32_bf16 v[152:155], a[128:131], v[180:183], v[152:155]
    ds_read_b128 v[168:171], v5 offset:384
    v_mfma_f32_16x16x32_bf16 v[152:155], a[192:195], v[184:187], v[152:155]
    ds_read_b128 v[172:175], v5 offset:1664
    s_waitcnt lgkmcnt(5)
    v_mfma_f32_16x16x32_bf16 v[200:203], a[16:19], v[188:191], 0
    ds_read_b128 v[176:179], v5 offset:2944
    ds_read_b64_tr_b16 a[32:33], v6 offset:2080
    v_mfma_f32_16x16x32_bf16 v[204:207], a[24:27], v[188:191], 0
    ds_read_b64_tr_b16 a[34:35], v6 offset:2048
    v_mfma_f32_16x16x32_bf16 v[200:203], a[80:83], v[192:195], v[200:203]
    ds_read_b128 v[180:183], v5 offset:4224
    ds_read_b64_tr_b16 a[96:97], v6 offset:6240
    v_cvt_pk_bf16_f32 v158, v152, v153
    v_mfma_f32_16x16x32_bf16 v[204:207], a[88:91], v[192:195], v[204:207]
    ds_read_b64_tr_b16 a[98:99], v6 offset:6208
    v_cvt_pk_bf16_f32 v159, v154, v155
    s_waitcnt lgkmcnt(8)
    v_mfma_f32_16x16x32_bf16 v[200:203], a[144:147], v[196:199], v[200:203]
    ds_read_b128 v[184:187], v5 offset:320
    ds_read_b64_tr_b16 a[160:161], v6 offset:10400
    ds_write_b64 v7, v[158:159] offset:1280
    v_mfma_f32_16x16x32_bf16 v[204:207], a[152:155], v[196:199], v[204:207]
    ds_read_b64_tr_b16 a[162:163], v6 offset:10368
    v_mfma_f32_16x16x32_bf16 v[200:203], a[208:211], v[164:167], v[200:203]
    ds_read_b128 v[188:191], v5 offset:1600
    ds_read_b64_tr_b16 a[224:225], v6 offset:14560
    v_mfma_f32_16x16x32_bf16 v[204:207], a[216:219], v[164:167], v[204:207]
    ds_read_b64_tr_b16 a[226:227], v6 offset:14528
    s_waitcnt lgkmcnt(13)
    v_mfma_f32_16x16x32_bf16 v[200:203], a[20:23], v[168:171], v[200:203]
    ds_read_b128 v[192:195], v5 offset:2880
    ds_read_b64_tr_b16 a[36:37], v6 offset:2336
    s_waitcnt vmcnt(0)
    s_waitcnt lgkmcnt(6)
    s_barrier
    v_mfma_f32_16x16x32_bf16 v[204:207], a[28:31], v[168:171], v[204:207]
    ds_read_b64_tr_b16 a[38:39], v6 offset:2304
    ds_read_b128 v[160:163], v8
    v_mfma_f32_16x16x32_bf16 v[200:203], a[84:87], v[172:175], v[200:203]
    ds_read_b128 v[196:199], v5 offset:4160
    ds_read_b64_tr_b16 a[100:101], v6 offset:6496
    v_mfma_f32_16x16x32_bf16 v[204:207], a[92:95], v[172:175], v[204:207]
    ds_read_b64_tr_b16 a[102:103], v6 offset:6464
    buffer_load_dwordx4 v[144:147], v2, s[12:15], s74 offen sc1
    v_mfma_f32_16x16x32_bf16 v[200:203], a[148:151], v[176:179], v[200:203]
    ds_read_b128 v[164:167], v5 offset:256
    ds_read_b64_tr_b16 a[164:165], v6 offset:10656
    v_mfma_f32_16x16x32_bf16 v[204:207], a[156:159], v[176:179], v[204:207]
    ds_read_b64_tr_b16 a[166:167], v6 offset:10624
    s_waitcnt lgkmcnt(6)
    buffer_store_dwordx4 v[160:163], v1, s[12:15], s75 offen sc1
    v_mfma_f32_16x16x32_bf16 v[200:203], a[212:215], v[180:183], v[200:203]
    ds_read_b128 v[168:171], v5 offset:1536
    ds_read_b64_tr_b16 a[228:229], v6 offset:14816
    v_mfma_f32_16x16x32_bf16 v[204:207], a[220:223], v[180:183], v[204:207]
    ds_read_b64_tr_b16 a[230:231], v6 offset:14784
    v_mfma_f32_16x16x32_bf16 v[200:203], a[24:27], v[184:187], v[200:203]
    ds_read_b128 v[172:175], v5 offset:2816
    ds_read_b64_tr_b16 a[40:41], v6 offset:2592
    v_mfma_f32_16x16x32_bf16 v[204:207], a[32:35], v[184:187], v[204:207]
    ds_read_b64_tr_b16 a[42:43], v6 offset:2560
    v_mfma_f32_16x16x32_bf16 v[200:203], a[88:91], v[188:191], v[200:203]
    ds_read_b128 v[176:179], v5 offset:4096
    ds_read_b64_tr_b16 a[104:105], v6 offset:6752
    v_mfma_f32_16x16x32_bf16 v[204:207], a[96:99], v[188:191], v[204:207]
    ds_read_b64_tr_b16 a[106:107], v6 offset:6720
    s_waitcnt lgkmcnt(14)
    v_mfma_f32_16x16x32_bf16 v[200:203], a[152:155], v[192:195], v[200:203]
    ds_read_b128 v[180:183], v5 offset:192
    ds_read_b64_tr_b16 a[168:169], v6 offset:10912
    v_mfma_f32_16x16x32_bf16 v[204:207], a[160:163], v[192:195], v[204:207]
    ds_read_b64_tr_b16 a[170:171], v6 offset:10880
    v_mfma_f32_16x16x32_bf16 v[200:203], a[216:219], v[196:199], v[200:203]
    ds_read_b128 v[184:187], v5 offset:1472
    ds_read_b64_tr_b16 a[232:233], v6 offset:15072
    v_mfma_f32_16x16x32_bf16 v[204:207], a[224:227], v[196:199], v[204:207]
    ds_read_b64_tr_b16 a[234:235], v6 offset:15040
    s_waitcnt lgkmcnt(14)
    v_mfma_f32_16x16x32_bf16 v[200:203], a[28:31], v[164:167], v[200:203]
    ds_read_b128 v[188:191], v5 offset:2752
    ds_read_b64_tr_b16 a[44:45], v6 offset:2848
    v_mfma_f32_16x16x32_bf16 v[204:207], a[36:39], v[164:167], v[204:207]
    ds_read_b64_tr_b16 a[46:47], v6 offset:2816
    v_mfma_f32_16x16x32_bf16 v[200:203], a[92:95], v[168:171], v[200:203]
    ds_read_b128 v[192:195], v5 offset:4032
    ds_read_b64_tr_b16 a[108:109], v6 offset:7008
    v_mfma_f32_16x16x32_bf16 v[204:207], a[100:103], v[168:171], v[204:207]
    ds_read_b64_tr_b16 a[110:111], v6 offset:6976
    s_waitcnt lgkmcnt(14)
    v_mfma_f32_16x16x32_bf16 v[200:203], a[156:159], v[172:175], v[200:203]
    ds_read_b128 v[196:199], v5 offset:128
    ds_read_b64_tr_b16 a[172:173], v6 offset:11168
    v_mfma_f32_16x16x32_bf16 v[204:207], a[164:167], v[172:175], v[204:207]
    ds_read_b64_tr_b16 a[174:175], v6 offset:11136
    v_mfma_f32_16x16x32_bf16 v[200:203], a[220:223], v[176:179], v[200:203]
    ds_read_b128 v[164:167], v5 offset:1408
    ds_read_b64_tr_b16 a[236:237], v6 offset:15328
    v_mfma_f32_16x16x32_bf16 v[204:207], a[228:231], v[176:179], v[204:207]
    ds_read_b64_tr_b16 a[238:239], v6 offset:15296
    s_waitcnt lgkmcnt(14)
    v_mfma_f32_16x16x32_bf16 v[200:203], a[32:35], v[180:183], v[200:203]
    ds_read_b128 v[168:171], v5 offset:2688
    ds_read_b64_tr_b16 a[48:49], v6 offset:3104
    v_mfma_f32_16x16x32_bf16 v[204:207], a[40:43], v[180:183], v[204:207]
    ds_read_b64_tr_b16 a[50:51], v6 offset:3072
    v_mfma_f32_16x16x32_bf16 v[200:203], a[96:99], v[184:187], v[200:203]
    ds_read_b128 v[172:175], v5 offset:3968
    ds_read_b64_tr_b16 a[112:113], v6 offset:7264
    v_mfma_f32_16x16x32_bf16 v[204:207], a[104:107], v[184:187], v[204:207]
    ds_read_b64_tr_b16 a[114:115], v6 offset:7232
    s_waitcnt lgkmcnt(14)
    v_mfma_f32_16x16x32_bf16 v[200:203], a[160:163], v[188:191], v[200:203]
    ds_read_b128 v[176:179], v5 offset:64
    ds_read_b64_tr_b16 a[176:177], v6 offset:11424
    v_mfma_f32_16x16x32_bf16 v[204:207], a[168:171], v[188:191], v[204:207]
    ds_read_b64_tr_b16 a[178:179], v6 offset:11392
    v_mfma_f32_16x16x32_bf16 v[200:203], a[224:227], v[192:195], v[200:203]
    ds_read_b128 v[180:183], v5 offset:1344
    ds_read_b64_tr_b16 a[240:241], v6 offset:15584
    v_mfma_f32_16x16x32_bf16 v[204:207], a[232:235], v[192:195], v[204:207]
    ds_read_b64_tr_b16 a[242:243], v6 offset:15552
    s_waitcnt lgkmcnt(14)
    v_mfma_f32_16x16x32_bf16 v[200:203], a[36:39], v[196:199], v[200:203]
    ds_read_b128 v[184:187], v5 offset:2624
    ds_read_b64_tr_b16 a[52:53], v6 offset:3360
    v_mfma_f32_16x16x32_bf16 v[204:207], a[44:47], v[196:199], v[204:207]
    ds_read_b64_tr_b16 a[54:55], v6 offset:3328
    v_mfma_f32_16x16x32_bf16 v[200:203], a[100:103], v[164:167], v[200:203]
    ds_read_b128 v[188:191], v5 offset:3904
    ds_read_b64_tr_b16 a[116:117], v6 offset:7520
    v_mfma_f32_16x16x32_bf16 v[204:207], a[108:111], v[164:167], v[204:207]
    ds_read_b64_tr_b16 a[118:119], v6 offset:7488
    s_waitcnt lgkmcnt(14)
    v_mfma_f32_16x16x32_bf16 v[200:203], a[164:167], v[168:171], v[200:203]
    ds_read_b128 v[192:195], v5 offset:0
    ds_read_b64_tr_b16 a[180:181], v6 offset:11680
    v_mfma_f32_16x16x32_bf16 v[204:207], a[172:175], v[168:171], v[204:207]
    ds_read_b64_tr_b16 a[182:183], v6 offset:11648
    v_mfma_f32_16x16x32_bf16 v[200:203], a[228:231], v[172:175], v[200:203]
    ds_read_b128 v[196:199], v5 offset:1280
    ds_read_b64_tr_b16 a[244:245], v6 offset:15840
    v_mfma_f32_16x16x32_bf16 v[204:207], a[236:239], v[172:175], v[204:207]
    ds_read_b64_tr_b16 a[246:247], v6 offset:15808
    s_waitcnt lgkmcnt(14)
    v_mfma_f32_16x16x32_bf16 v[200:203], a[40:43], v[176:179], v[200:203]
    ds_read_b128 v[164:167], v5 offset:2560
    v_mfma_f32_16x16x32_bf16 v[204:207], a[48:51], v[176:179], v[204:207]
    v_mfma_f32_16x16x32_bf16 v[200:203], a[104:107], v[180:183], v[200:203]
    ds_read_b128 v[168:171], v5 offset:3840
    v_mfma_f32_16x16x32_bf16 v[204:207], a[112:115], v[180:183], v[204:207]
    s_waitcnt vmcnt(1)
    v_max3_u32 v12, v144, v145, v146
    s_waitcnt lgkmcnt(10)
    v_mfma_f32_16x16x32_bf16 v[200:203], a[168:171], v[184:187], v[200:203]
    v_max_u32 v12, v12, v147
    v_cmp_eq_u32 vcc, -1, v12
    v_mfma_f32_16x16x32_bf16 v[204:207], a[176:179], v[184:187], v[204:207]
    s_cbranch_vccnz L_h1_rt_18
L_h1_ok_19:
    v_mfma_f32_16x16x32_bf16 v[200:203], a[232:235], v[188:191], v[200:203]
    ds_write2st64_b32 v4, v144, v145 offset0:2 offset1:7
    v_mfma_f32_16x16x32_bf16 v[204:207], a[240:243], v[188:191], v[204:207]
    ds_write2st64_b32 v4, v146, v147 offset0:12 offset1:17
    s_waitcnt lgkmcnt(6)
    v_mfma_f32_16x16x32_bf16 v[200:203], a[44:47], v[192:195], v[200:203]
    ds_write2st64_b32 v130, v144, v145 offset0:2 offset1:7
    v_mfma_f32_16x16x32_bf16 v[204:207], a[52:55], v[192:195], v[204:207]
    ds_write2st64_b32 v130, v146, v147 offset0:12 offset1:17
    v_mfma_f32_16x16x32_bf16 v[200:203], a[108:111], v[196:199], v[200:203]
    v_mfma_f32_16x16x32_bf16 v[204:207], a[116:119], v[196:199], v[204:207]
    s_waitcnt lgkmcnt(4)
    v_mfma_f32_16x16x32_bf16 v[200:203], a[172:175], v[164:167], v[200:203]
    s_waitcnt lgkmcnt(0)
    s_barrier
    v_mfma_f32_16x16x32_bf16 v[204:207], a[180:183], v[164:167], v[204:207]
    ds_read_b128 v[172:175], v5 offset:512
    v_mfma_f32_16x16x32_bf16 v[200:203], a[236:239], v[168:171], v[200:203]
    ds_read_b128 v[176:179], v5 offset:1792
    v_mfma_f32_16x16x32_bf16 v[204:207], a[244:247], v[168:171], v[204:207]
    ds_read_b128 v[180:183], v5 offset:3072
    s_waitcnt lgkmcnt(1)
    v_mfma_f32_16x16x32_bf16 v[204:207], a[20:23], v[172:175], v[204:207]
    ds_read_b128 v[184:187], v5 offset:4352
    v_mfma_f32_16x16x32_bf16 v[200:203], a[12:15], v[172:175], v[200:203]
    ds_read_b128 v[188:191], v5 offset:576
    v_mfma_f32_16x16x32_bf16 v[204:207], a[84:87], v[176:179], v[204:207]
    ds_read_b128 v[192:195], v5 offset:1856
    v_mfma_f32_16x16x32_bf16 v[200:203], a[76:79], v[176:179], v[200:203]
    ds_read_b128 v[196:199], v5 offset:3136
    s_waitcnt lgkmcnt(3)
    v_mfma_f32_16x16x32_bf16 v[204:207], a[148:151], v[180:183], v[204:207]
    ds_read_b128 v[164:167], v5 offset:4416
    v_mfma_f32_16x16x32_bf16 v[200:203], a[140:143], v[180:183], v[200:203]
    ds_read_b128 v[168:171], v5 offset:640
    v_mfma_f32_16x16x32_bf16 v[204:207], a[212:215], v[184:187], v[204:207]
    ds_read_b128 v[172:175], v5 offset:1920
    v_mfma_f32_16x16x32_bf16 v[200:203], a[204:207], v[184:187], v[200:203]
    s_waitcnt lgkmcnt(4)
    v_mfma_f32_16x16x32_bf16 v[204:207], a[16:19], v[188:191], v[204:207]
    ds_read_b128 v[176:179], v5 offset:3200
    v_mfma_f32_16x16x32_bf16 v[200:203], a[8:11], v[188:191], v[200:203]
    v_mfma_f32_16x16x32_bf16 v[204:207], a[80:83], v[192:195], v[204:207]
    ds_read_b128 v[180:183], v5 offset:4480
    v_mfma_f32_16x16x32_bf16 v[200:203], a[72:75], v[192:195], v[200:203]
    s_waitcnt lgkmcnt(4)
    v_mfma_f32_16x16x32_bf16 v[204:207], a[144:147], v[196:199], v[204:207]
    ds_read_b128 v[184:187], v5 offset:704
    v_mfma_f32_16x16x32_bf16 v[200:203], a[136:139], v[196:199], v[200:203]
    v_mfma_f32_16x16x32_bf16 v[204:207], a[208:211], v[164:167], v[204:207]
    ds_read_b128 v[188:191], v5 offset:1984
    v_mfma_f32_16x16x32_bf16 v[200:203], a[200:203], v[164:167], v[200:203]
    s_mov_b64 exec, s[92:93]
    buffer_load_dwordx4 v[120:123], v2, s[12:15], s72 offen sc1
    buffer_load_dwordx4 v[124:127], v3, s[12:15], s72 offen sc1
    s_mov_b64 exec, -1
    s_waitcnt lgkmcnt(4)
    v_mfma_f32_16x16x32_bf16 v[204:207], a[12:15], v[168:171], v[204:207]
    ds_read_b128 v[192:195], v5 offset:3264
    v_mfma_f32_16x16x32_bf16 v[200:203], a[4:7], v[168:171], v[200:203]
    v_mfma_f32_16x16x32_bf16 v[204:207], a[76:79], v[172:175], v[204:207]
    ds_read_b128 v[196:199], v5 offset:4544
    v_mfma_f32_16x16x32_bf16 v[200:203], a[68:71], v[172:175], v[200:203]
    s_waitcnt lgkmcnt(4)
    v_mfma_f32_16x16x32_bf16 v[204:207], a[140:143], v[176:179], v[204:207]
    ds_read_b128 v[164:167], v5 offset:768
    v_mfma_f32_16x16x32_bf16 v[200:203], a[132:135], v[176:179], v[200:203]
    v_mfma_f32_16x16x32_bf16 v[204:207], a[204:207], v[180:183], v[204:207]
    ds_read_b128 v[168:171], v5 offset:2048
    v_mfma_f32_16x16x32_bf16 v[200:203], a[196:199], v[180:183], v[200:203]
    s_waitcnt lgkmcnt(4)
    v_mfma_f32_16x16x32_bf16 v[204:207], a[8:11], v[184:187], v[204:207]
    ds_read_b128 v[172:175], v5 offset:3328
    v_mfma_f32_16x16x32_bf16 v[200:203], a[0:3], v[184:187], v[200:203]
    v_mfma_f32_16x16x32_bf16 v[204:207], a[72:75], v[188:191], v[204:207]
    ds_read_b128 v[176:179], v5 offset:4608
    v_mfma_f32_16x16x32_bf16 v[200:203], a[64:67], v[188:191], v[200:203]
    s_waitcnt lgkmcnt(4)
    v_mfma_f32_16x16x32_bf16 v[204:207], a[136:139], v[192:195], v[204:207]
    ds_read_b128 v[180:183], v5 offset:832
    v_mfma_f32_16x16x32_bf16 v[200:203], a[128:131], v[192:195], v[200:203]
    v_mfma_f32_16x16x32_bf16 v[204:207], a[200:203], v[196:199], v[204:207]
    ds_read_b128 v[184:187], v5 offset:2112
    v_mfma_f32_16x16x32_bf16 v[200:203], a[192:195], v[196:199], v[200:203]
    s_waitcnt lgkmcnt(4)
    v_mfma_f32_16x16x32_bf16 v[204:207], a[4:7], v[164:167], v[204:207]
    ds_read_b128 v[188:191], v5 offset:3392
    v_mfma_f32_16x16x32_bf16 v[204:207], a[68:71], v[168:171], v[204:207]
    ds_read_b128 v[192:195], v5 offset:4672
    s_waitcnt lgkmcnt(4)
    v_mfma_f32_16x16x32_bf16 v[204:207], a[132:135], v[172:175], v[204:207]
    s_nop 0
    v_cvt_pk_bf16_f32 v156, v200, v201
    v_mfma_f32_16x16x32_bf16 v[204:207], a[196:199], v[176:179], v[204:207]
    v_cvt_pk_bf16_f32 v157, v202, v203
    s_waitcnt lgkmcnt(2)
    v_mfma_f32_16x16x32_bf16 v[204:207], a[0:3], v[180:183], v[204:207]
    ds_write_b64 v7, v[156:157] offset:5120
    v_mfma_f32_16x16x32_bf16 v[204:207], a[64:67], v[184:187], v[204:207]
    s_waitcnt lgkmcnt(1)
    v_mfma_f32_16x16x32_bf16 v[204:207], a[128:131], v[188:191], v[204:207]
    v_mfma_f32_16x16x32_bf16 v[204:207], a[192:195], v[192:195], v[204:207]
    s_lshl_b32 s57, s84, 22
    s_add_u32 s73, s57, s79
    s_add_u32 s73, s73, 4194304
    s_add_u32 s74, s57, s80
    s_add_u32 s74, s74, 4194304
    s_add_u32 s75, s75, 4096
    s_nop 1
    v_cvt_pk_bf16_f32 v158, v204, v205
    v_cvt_pk_bf16_f32 v159, v206, v207
    ds_write_b64 v7, v[158:159] offset:6400
L_ctailB:
    s_waitcnt lgkmcnt(0)
    s_barrier
    ds_read_b128 v[160:163], v8 offset:5120
    s_waitcnt lgkmcnt(0)
    buffer_store_dwordx4 v[160:163], v1, s[12:15], s75 offen sc1
    s_add_u32 s75, s57, s81
    s_add_u32 s75, s75, 6291456
    s_add_u32 s84, s84, 1
    s_cmp_eq_u32 s84, 3
    s_cbranch_scc1 L_r6
    s_cmp_eq_u32 s6, 0
    s_cbranch_scc1 L_nosl_20
    s_sleep 16
    buffer_load_dwordx4 v[120:123], v2, s[12:15], s72 offen sc1
    buffer_load_dwordx4 v[124:127], v3, s[12:15], s72 offen sc1
    s_waitcnt vmcnt(0)
L_nosl_20:
    s_waitcnt vmcnt(1)
L_r4_chk_21:
    v_max3_u32 v12, v120, v121, v122
    v_max3_u32 v12, v12, v123, v124
    v_max3_u32 v12, v12, v125, v126
    v_max_u32 v12, v12, v127
    v_cmp_eq_u32 vcc, -1, v12
    s_nop 0
    s_cbranch_vccnz L_r4_rt_22
L_r4_ok_23:
    v_dot2_f32_bf16 v88, v120, s64, v48
    v_dot2_f32_bf16 v89, v124, s64, v49
    v_dot2_f32_bf16 v90, v120, s65, v50
    v_dot2_f32_bf16 v91, v124, s65, v51
    v_dot2_f32_bf16 v92, v121, s64, v52
    v_dot2_f32_bf16 v93, v125, s64, v53
    v_dot2_f32_bf16 v94, v121, s65, v54
    v_dot2_f32_bf16 v95, v125, s65, v55
    v_dot2_f32_bf16 v96, v122, s64, v56
    v_dot2_f32_bf16 v97, v126, s64, v57
    v_dot2_f32_bf16 v98, v122, s65, v58
    v_dot2_f32_bf16 v99, v126, s65, v59
    v_dot2_f32_bf16 v100, v123, s64, v60
    v_dot2_f32_bf16 v101, v127, s64, v61
    v_dot2_f32_bf16 v102, v123, s65, v62
    v_dot2_f32_bf16 v103, v127, s65, v63
    v_cvt_pk_bf16_f32 v80, v88, v89
    v_cvt_pk_bf16_f32 v81, v90, v91
    v_cvt_pk_bf16_f32 v82, v92, v93
    v_cvt_pk_bf16_f32 v83, v94, v95
    v_cvt_pk_bf16_f32 v84, v96, v97
    v_cvt_pk_bf16_f32 v85, v98, v99
    v_cvt_pk_bf16_f32 v86, v100, v101
    v_cvt_pk_bf16_f32 v87, v102, v103
    v_dot2_f32_bf16 v88, v80, s66, 0
    v_dot2_f32_bf16 v89, v81, s66, 0
    v_dot2_f32_bf16 v90, v82, s66, 0
    v_dot2_f32_bf16 v91, v83, s66, 0
    v_dot2_f32_bf16 v92, v84, s66, 0
    v_dot2_f32_bf16 v93, v85, s66, 0
    v_dot2_f32_bf16 v94, v86, s66, 0
    v_dot2_f32_bf16 v95, v87, s66, 0
    v_dot2_f32_bf16 v96, v80, v80, 0
    v_dot2_f32_bf16 v97, v81, v81, 0
    v_dot2_f32_bf16 v98, v82, v82, 0
    v_dot2_f32_bf16 v99, v83, v83, 0
    v_dot2_f32_bf16 v100, v84, v84, 0
    v_dot2_f32_bf16 v101, v85, v85, 0
    v_dot2_f32_bf16 v102, v86, v86, 0
    v_dot2_f32_bf16 v103, v87, v87, 0
    v_add_f32_dpp v88, v88, v88 row_shl:8 row_mask:0xf bank_mask:0x3
    v_add_f32_dpp v89, v89, v89 row_shl:8 row_mask:0xf bank_mask:0x3
    v_add_f32_dpp v90, v90, v90 row_shl:8 row_mask:0xf bank_mask:0x3
    v_add_f32_dpp v91, v91, v91 row_shl:8 row_mask:0xf bank_mask:0x3
    v_add_f32_dpp v92, v92, v92 row_shl:8 row_mask:0xf bank_mask:0x3
    v_add_f32_dpp v93, v93, v93 row_shl:8 row_mask:0xf bank_mask:0x3
    v_add_f32_dpp v94, v94, v94 row_shl:8 row_mask:0xf bank_mask:0x3
    v_add_f32_dpp v95, v95, v95 row_shl:8 row_mask:0xf bank_mask:0x3
    v_add_f32_dpp v88, v96, v96 row_shr:8 row_mask:0xf bank_mask:0xc
    v_add_f32_dpp v89, v97, v97 row_shr:8 row_mask:0xf bank_mask:0xc
    v_add_f32_dpp v90, v98, v98 row_shr:8 row_mask:0xf bank_mask:0xc
    v_add_f32_dpp v91, v99, v99 row_shr:8 row_mask:0xf bank_mask:0xc
    v_add_f32_dpp v92, v100, v100 row_shr:8 row_mask:0xf bank_mask:0xc
    v_add_f32_dpp v93, v101, v101 row_shr:8 row_mask:0xf bank_mask:0xc
    v_add_f32_dpp v94, v102, v102 row_shr:8 row_mask:0xf bank_mask:0xc
    v_add_f32_dpp v95, v103, v103 row_shr:8 row_mask:0xf bank_mask:0xc
    v_add_f32_dpp v88, v88, v88 row_shl:4 row_mask:0xf bank_mask:0x5
    v_add_f32_dpp v89, v89, v89 row_shl:4 row_mask:0xf bank_mask:0x5
    v_add_f32_dpp v90, v90, v90 row_shl:4 row_mask:0xf bank_mask:0x5
    v_add_f32_dpp v91, v91, v91 row_shl:4 row_mask:0xf bank_mask:0x5
    v_add_f32_dpp v88, v92, v92 row_shr:4 row_mask:0xf bank_mask:0xa
    v_add_f32_dpp v89, v93, v93 row_shr:4 row_mask:0xf bank_mask:0xa
    v_add_f32_dpp v90, v94, v94 row_shr:4 row_mask:0xf bank_mask:0xa
    v_add_f32_dpp v91, v95, v95 row_shr:4 row_mask:0xf bank_mask:0xa
    v_lshlrev_b32 v16, 16, v80
    v_permlane16_swap_b32 v88, v90
    v_permlane16_swap_b32 v89, v91
    v_add_f32 v88, v88, v90
    v_add_f32 v89, v89, v91
    v_and_b32 v17, 0xffff0000, v80
    v_lshlrev_b32 v18, 16, v81
    v_permlane32_swap_b32 v88, v89
    v_add_f32 v88, v88, v89
    v_and_b32 v19, 0xffff0000, v81
    v_lshlrev_b32 v20, 16, v82
    v_add_f32_dpp v88, v88, v88 quad_perm:[1,0,3,2] row_mask:0xf bank_mask:0xf
    v_and_b32 v21, 0xffff0000, v82
    v_lshlrev_b32 v22, 16, v83
    v_add_f32_dpp v88, v88, v88 quad_perm:[2,3,0,1] row_mask:0xf bank_mask:0xf
    ds_write_b32 v9, v88
    v_and_b32 v23, 0xffff0000, v83
    v_lshlrev_b32 v24, 16, v84
    v_and_b32 v25, 0xffff0000, v84
    v_lshlrev_b32 v26, 16, v85
    v_and_b32 v27, 0xffff0000, v85
    v_lshlrev_b32 v28, 16, v86
    v_and_b32 v29, 0xffff0000, v86
    v_lshlrev_b32 v30, 16, v87
    v_and_b32 v31, 0xffff0000, v87
    s_waitcnt lgkmcnt(0)
    s_barrier
    ds_read_b128 v[88:91], v10
    ds_read_b128 v[92:95], v10 offset:16
    v_xor_b32 v9, 256, v9
    v_xor_b32 v10, 256, v10
    s_waitcnt lgkmcnt(1)
    v_add_f32 v88, v88, v89
    v_add_f32 v90, v90, v91
    s_waitcnt lgkmcnt(0)
    v_add_f32 v92, v92, v93
    v_add_f32 v94, v94, v95
    v_add_f32 v88, v88, v90
    v_add_f32 v92, v92, v94
    v_mul_f32 v88, s83, v88
    v_mul_f32 v92, s83, v92
    v_fma_f32 v92, -v88, v88, v92
    v_max_f32 v92, 0, v92
    v_add_f32 v92, 0x3727c5ac, v92
    v_rsq_f32 v13, v92
    s_nop 0
    s_nop 0
    v_mul_f32_e64 v12, -v88, v13
    v_readlane_b32 s16, v13, 0
    v_readlane_b32 s17, v12, 0
    v_readlane_b32 s18, v13, 1
    v_readlane_b32 s19, v12, 1
    v_readlane_b32 s20, v13, 2
    v_readlane_b32 s21, v12, 2
    v_readlane_b32 s22, v13, 3
    v_readlane_b32 s23, v12, 3
    v_readlane_b32 s24, v13, 4
    v_readlane_b32 s25, v12, 4
    v_readlane_b32 s26, v13, 5
    v_readlane_b32 s27, v12, 5
    v_readlane_b32 s28, v13, 6
    v_readlane_b32 s29, v12, 6
    v_readlane_b32 s30, v13, 7
    v_readlane_b32 s31, v12, 7
    v_pk_fma_f32 v[104:105], v[16:17], s[16:17], s[16:17] op_sel:[0,0,1] op_sel_hi:[1,0,1]
    v_pk_fma_f32 v[106:107], v[18:19], s[18:19], s[18:19] op_sel:[0,0,1] op_sel_hi:[1,0,1]
    v_pk_fma_f32 v[108:109], v[20:21], s[20:21], s[20:21] op_sel:[0,0,1] op_sel_hi:[1,0,1]
    v_pk_fma_f32 v[110:111], v[22:23], s[22:23], s[22:23] op_sel:[0,0,1] op_sel_hi:[1,0,1]
    v_pk_fma_f32 v[112:113], v[24:25], s[24:25], s[24:25] op_sel:[0,0,1] op_sel_hi:[1,0,1]
    v_pk_fma_f32 v[114:115], v[26:27], s[26:27], s[26:27] op_sel:[0,0,1] op_sel_hi:[1,0,1]
    v_pk_fma_f32 v[116:117], v[28:29], s[28:29], s[28:29] op_sel:[0,0,1] op_sel_hi:[1,0,1]
    v_pk_fma_f32 v[118:119], v[30:31], s[30:31], s[30:31] op_sel:[0,0,1] op_sel_hi:[1,0,1]
    v_pk_fma_f32 v[88:89], v[104:105], v[32:33], v[16:17]
    v_pk_fma_f32 v[90:91], v[106:107], v[34:35], v[18:19]
    v_pk_fma_f32 v[92:93], v[108:109], v[36:37], v[20:21]
    v_pk_fma_f32 v[94:95], v[110:111], v[38:39], v[22:23]
    v_pk_fma_f32 v[96:97], v[112:113], v[40:41], v[24:25]
    v_pk_fma_f32 v[98:99], v[114:115], v[42:43], v[26:27]
    v_pk_fma_f32 v[100:101], v[116:117], v[44:45], v[28:29]
    v_pk_fma_f32 v[102:103], v[118:119], v[46:47], v[30:31]
    v_cvt_pk_bf16_f32 v80, v88, v89
    v_cvt_pk_bf16_f32 v81, v90, v91
    v_cvt_pk_bf16_f32 v82, v92, v93
    v_cvt_pk_bf16_f32 v83, v94, v95
    v_cvt_pk_bf16_f32 v84, v96, v97
    v_cvt_pk_bf16_f32 v85, v98, v99
    v_cvt_pk_bf16_f32 v86, v100, v101
    v_cvt_pk_bf16_f32 v87, v102, v103
    v_dot2_f32_bf16 v88, v80, s66, 0
    v_dot2_f32_bf16 v89, v81, s66, 0
    v_dot2_f32_bf16 v90, v82, s66, 0
    v_dot2_f32_bf16 v91, v83, s66, 0
    v_dot2_f32_bf16 v92, v84, s66, 0
    v_dot2_f32_bf16 v93, v85, s66, 0
    v_dot2_f32_bf16 v94, v86, s66, 0
    v_dot2_f32_bf16 v95, v87, s66, 0
    v_dot2_f32_bf16 v96, v80, v80, 0
    v_dot2_f32_bf16 v97, v81, v81, 0
    v_dot2_f32_bf16 v98, v82, v82, 0
    v_dot2_f32_bf16 v99, v83, v83, 0
    v_dot2_f32_bf16 v100, v84, v84, 0
    v_dot2_f32_bf16 v101, v85, v85, 0
    v_dot2_f32_bf16 v102, v86, v86, 0
    v_dot2_f32_bf16 v103, v87, v87, 0
    v_add_f32_dpp v88, v88, v88 row_shl:8 row_mask:0xf bank_mask:0x3
    v_add_f32_dpp v89, v89, v89 row_shl:8 row_mask:0xf bank_mask:0x3
    v_add_f32_dpp v90, v90, v90 row_shl:8 row_mask:0xf bank_mask:0x3
    v_add_f32_dpp v91, v91, v91 row_shl:8 row_mask:0xf bank_mask:0x3
    v_add_f32_dpp v92, v92, v92 row_shl:8 row_mask:0xf bank_mask:0x3
    v_add_f32_dpp v93, v93, v93 row_shl:8 row_mask:0xf bank_mask:0x3
    v_add_f32_dpp v94, v94, v94 row_shl:8 row_mask:0xf bank_mask:0x3
    v_add_f32_dpp v95, v95, v95 row_shl:8 row_mask:0xf bank_mask:0x3
    v_add_f32_dpp v88, v96, v96 row_shr:8 row_mask:0xf bank_mask:0xc
    v_add_f32_dpp v89, v97, v97 row_shr:8 row_mask:0xf bank_mask:0xc
    v_add_f32_dpp v90, v98, v98 row_shr:8 row_mask:0xf bank_mask:0xc
    v_add_f32_dpp v91, v99, v99 row_shr:8 row_mask:0xf bank_mask:0xc
    v_add_f32_dpp v92, v100, v100 row_shr:8 row_mask:0xf bank_mask:0xc
    v_add_f32_dpp v93, v101, v101 row_shr:8 row_mask:0xf bank_mask:0xc
    v_add_f32_dpp v94, v102, v102 row_shr:8 row_mask:0xf bank_mask:0xc
    v_add_f32_dpp v95, v103, v103 row_shr:8 row_mask:0xf bank_mask:0xc
    v_add_f32_dpp v88, v88, v88 row_shl:4 row_mask:0xf bank_mask:0x5
    v_add_f32_dpp v89, v89, v89 row_shl:4 row_mask:0xf bank_mask:0x5
    v_add_f32_dpp v90, v90, v90 row_shl:4 row_mask:0xf bank_mask:0x5
    v_add_f32_dpp v91, v91, v91 row_shl:4 row_mask:0xf bank_mask:0x5
    v_add_f32_dpp v88, v92, v92 row_shr:4 row_mask:0xf bank_mask:0xa
    v_add_f32_dpp v89, v93, v93 row_shr:4 row_mask:0xf bank_mask:0xa
    v_add_f32_dpp v90, v94, v94 row_shr:4 row_mask:0xf bank_mask:0xa
    v_add_f32_dpp v91, v95, v95 row_shr:4 row_mask:0xf bank_mask:0xa
    v_lshlrev_b32 v16, 16, v80
    v_permlane16_swap_b32 v88, v90
    v_permlane16_swap_b32 v89, v91
    v_add_f32 v88, v88, v90
    v_add_f32 v89, v89, v91
    v_and_b32 v17, 0xffff0000, v80
    v_lshlrev_b32 v18, 16, v81
    v_permlane32_swap_b32 v88, v89
    v_add_f32 v88, v88, v89
    v_and_b32 v19, 0xffff0000, v81
    v_lshlrev_b32 v20, 16, v82
    v_add_f32_dpp v88, v88, v88 quad_perm:[1,0,3,2] row_mask:0xf bank_mask:0xf
    v_and_b32 v21, 0xffff0000, v82
    v_lshlrev_b32 v22, 16, v83
    v_add_f32_dpp v88, v88, v88 quad_perm:[2,3,0,1] row_mask:0xf bank_mask:0xf
    ds_write_b32 v9, v88
    v_and_b32 v23, 0xffff0000, v83
    v_lshlrev_b32 v24, 16, v84
    v_and_b32 v25, 0xffff0000, v84
    v_lshlrev_b32 v26, 16, v85
    v_and_b32 v27, 0xffff0000, v85
    v_lshlrev_b32 v28, 16, v86
    v_and_b32 v29, 0xffff0000, v86
    v_lshlrev_b32 v30, 16, v87
    v_and_b32 v31, 0xffff0000, v87
    s_cmp_eq_u32 s6, 0
    s_cbranch_scc1 L_hc_24
    buffer_load_dwordx4 v[144:147], v2, s[12:15], s74 offen sc1
L_hc_24:
    s_waitcnt lgkmcnt(0)
    s_barrier
    ds_read_b128 v[88:91], v10
    ds_read_b128 v[92:95], v10 offset:16
    v_xor_b32 v9, 256, v9
    v_xor_b32 v10, 256, v10
    s_waitcnt lgkmcnt(1)
    v_add_f32 v88, v88, v89
    v_add_f32 v90, v90, v91
    s_waitcnt lgkmcnt(0)
    v_add_f32 v92, v92, v93
    v_add_f32 v94, v94, v95
    v_add_f32 v88, v88, v90
    v_add_f32 v92, v92, v94
    v_mul_f32 v88, s83, v88
    v_mul_f32 v92, s83, v92
    v_fma_f32 v92, -v88, v88, v92
    v_max_f32 v92, 0, v92
    v_add_f32 v92, 0x3727c5ac, v92
    v_rsq_f32 v13, v92
    s_nop 0
    s_nop 0
    v_mul_f32_e64 v12, -v88, v13
    v_readlane_b32 s16, v13, 0
    v_readlane_b32 s17, v12, 0
    v_readlane_b32 s18, v13, 1
    v_readlane_b32 s19, v12, 1
    v_readlane_b32 s20, v13, 2
    v_readlane_b32 s21, v12, 2
    v_readlane_b32 s22, v13, 3
    v_readlane_b32 s23, v12, 3
    v_readlane_b32 s24, v13, 4
    v_readlane_b32 s25, v12, 4
    v_readlane_b32 s26, v13, 5
    v_readlane_b32 s27, v12, 5
    v_readlane_b32 s28, v13, 6
    v_readlane_b32 s29, v12, 6
    v_readlane_b32 s30, v13, 7
    v_readlane_b32 s31, v12, 7
    v_pk_fma_f32 v[104:105], v[16:17], s[16:17], s[16:17] op_sel:[0,0,1] op_sel_hi:[1,0,1]
    v_pk_fma_f32 v[106:107], v[18:19], s[18:19], s[18:19] op_sel:[0,0,1] op_sel_hi:[1,0,1]
    v_pk_fma_f32 v[108:109], v[20:21], s[20:21], s[20:21] op_sel:[0,0,1] op_sel_hi:[1,0,1]
    v_pk_fma_f32 v[110:111], v[22:23], s[22:23], s[22:23] op_sel:[0,0,1] op_sel_hi:[1,0,1]
    v_pk_fma_f32 v[112:113], v[24:25], s[24:25], s[24:25] op_sel:[0,0,1] op_sel_hi:[1,0,1]
    v_pk_fma_f32 v[114:115], v[26:27], s[26:27], s[26:27] op_sel:[0,0,1] op_sel_hi:[1,0,1]
    v_pk_fma_f32 v[116:117], v[28:29], s[28:29], s[28:29] op_sel:[0,0,1] op_sel_hi:[1,0,1]
    v_pk_fma_f32 v[118:119], v[30:31], s[30:31], s[30:31] op_sel:[0,0,1] op_sel_hi:[1,0,1]
    v_cvt_pk_bf16_f32 v88, v104, v112
    v_cvt_pk_bf16_f32 v89, v106, v114
    v_cvt_pk_bf16_f32 v90, v108, v116
    v_cvt_pk_bf16_f32 v91, v110, v118
    buffer_store_dwordx4 v[88:91], v1, s[12:15], s73 offen sc1
    v_cvt_pk_bf16_f32 v92, v105, v113
    v_cvt_pk_bf16_f32 v93, v107, v115
    v_cvt_pk_bf16_f32 v94, v109, v117
    v_cvt_pk_bf16_f32 v95, v111, v119
    buffer_store_dwordx4 v[92:95], v11, s[12:15], s73 offen sc1
    s_add_u32 s72, s72, 4194304
    v_pk_fma_f32 v[48:49], v[104:105], v[128:129], v[16:17]
    v_pk_fma_f32 v[50:51], v[106:107], v[128:129], v[18:19]
    v_pk_fma_f32 v[52:53], v[108:109], v[128:129], v[20:21]
    v_pk_fma_f32 v[54:55], v[110:111], v[128:129], v[22:23]
    v_pk_fma_f32 v[56:57], v[112:113], v[128:129], v[24:25]
    v_pk_fma_f32 v[58:59], v[114:115], v[128:129], v[26:27]
    v_pk_fma_f32 v[60:61], v[116:117], v[128:129], v[28:29]
    v_pk_fma_f32 v[62:63], v[118:119], v[128:129], v[30:31]
    s_cmp_lg_u32 s6, 0
    s_cbranch_scc1 L_conv
    s_sleep 15
    buffer_load_dwordx4 v[144:147], v2, s[12:15], s74 offen sc1
    s_waitcnt vmcnt(0)
    s_branch L_conv
L_kg2:
    s_lshr_b32 s56, s5, 1
    s_mul_i32 s57, s56, 28832
    s_add_u32 s57, s57, 31744
    v_and_b32 v12, 15, v0
    v_bfe_u32 v13, v0, 4, 2
    v_mul_u32_u24 v14, 544, v12
    v_lshl_add_u32 v14, v13, 4, v14
    v_add_u32 v14, s57, v14
    s_mul_i32 s58, s77, 8704
    v_add_u32_e64 v15, s58, v14
    ds_read_b128 v[212:215], v15 offset:0
    ds_read_b128 v[148:151], v14 offset:17408
    ds_read_b128 v[152:155], v14 offset:26112
    ds_read_b128 v[216:219], v15 offset:64
    ds_read_b128 v[156:159], v14 offset:17472
    ds_read_b128 v[160:163], v14 offset:26176
    ds_read_b128 v[220:223], v15 offset:128
    ds_read_b128 v[164:167], v14 offset:17536
    ds_read_b128 v[168:171], v14 offset:26240
    ds_read_b128 v[224:227], v15 offset:192
    ds_read_b128 v[172:175], v14 offset:17600
    ds_read_b128 v[176:179], v14 offset:26304
    ds_read_b128 v[228:231], v15 offset:256
    ds_read_b128 v[180:183], v14 offset:17664
    ds_read_b128 v[184:187], v14 offset:26368
    s_mul_i32 s57, s56, 5776
    s_mul_i32 s58, s77, 320
    s_add_u32 s57, s57, s58
    s_add_u32 s57, s57, 144464
    v_mul_u32_u24 v12, 20, v12
    v_add_u32 v12, s57, v12
    v_cmp_eq_u32 vcc, 1, v13
    v_cmp_eq_u32 s[62:63], 2, v13
    v_mov_b32 v92, 640
    v_mov_b32 v93, 1280
    v_cndmask_b32 v88, 0, 8, vcc
    v_cmp_eq_u32 vcc, 3, v13
    v_cndmask_b32 v88, v88, v92, s[62:63]
    v_cndmask_b32 v89, 2, 4, s[62:63]
    v_cndmask_b32 v90, 4, 8, s[62:63]
    v_cndmask_b32 v88, v88, v93, vcc
    v_cndmask_b32 v89, v89, 8, vcc
    v_cndmask_b32 v90, v90, v92, vcc
    v_add_u32 v88, v88, v12
    v_add_u32 v91, v89, v90
    v_add_u32 v89, v89, v88
    v_add_u32 v90, v90, v88
    v_add_u32 v91, v91, v88
    v_mul_u32_u24 v92, 2560, v13
    v_add_u32 v92, v92, v12
    v_mul_u32_u24 v93, 48, v0
    v_add_u32 v93, 122688, v93
    s_waitcnt lgkmcnt(12)
    v_mfma_f32_16x16x32_bf16 v[244:247], v[148:151], v[212:215], 0
    v_mfma_f32_16x16x32_bf16 v[248:251], v[152:155], v[212:215], 0
    ds_read_b128 v[232:235], v15 offset:320
    ds_read_b128 v[188:191], v14 offset:17728
    ds_read_b128 v[192:195], v14 offset:26432
    s_waitcnt lgkmcnt(12)
    v_mfma_f32_16x16x32_bf16 v[244:247], v[156:159], v[216:219], v[244:247]
    v_mfma_f32_16x16x32_bf16 v[248:251], v[160:163], v[216:219], v[248:251]
    ds_read_b128 v[236:239], v15 offset:384
    ds_read_b128 v[196:199], v14 offset:17792
    ds_read_b128 v[200:203], v14 offset:26496
    s_waitcnt lgkmcnt(12)
    v_mfma_f32_16x16x32_bf16 v[244:247], v[164:167], v[220:223], v[244:247]
    v_mfma_f32_16x16x32_bf16 v[248:251], v[168:171], v[220:223], v[248:251]
    ds_read_b128 v[240:243], v15 offset:448
    ds_read_b128 v[204:207], v14 offset:17856
    ds_read_b128 v[208:211], v14 offset:26560
    s_waitcnt lgkmcnt(12)
    v_mfma_f32_16x16x32_bf16 v[244:247], v[172:175], v[224:227], v[244:247]
    v_mfma_f32_16x16x32_bf16 v[248:251], v[176:179], v[224:227], v[248:251]
    s_waitcnt lgkmcnt(9)
    v_mfma_f32_16x16x32_bf16 v[244:247], v[180:183], v[228:231], v[244:247]
    v_mfma_f32_16x16x32_bf16 v[248:251], v[184:187], v[228:231], v[248:251]
    s_waitcnt lgkmcnt(6)
    v_mfma_f32_16x16x32_bf16 v[244:247], v[188:191], v[232:235], v[244:247]
    v_mfma_f32_16x16x32_bf16 v[248:251], v[192:195], v[232:235], v[248:251]
    s_waitcnt lgkmcnt(3)
    v_mfma_f32_16x16x32_bf16 v[244:247], v[196:199], v[236:239], v[244:247]
    v_mfma_f32_16x16x32_bf16 v[248:251], v[200:203], v[236:239], v[248:251]
    s_waitcnt lgkmcnt(0)
    v_mfma_f32_16x16x32_bf16 v[244:247], v[204:207], v[240:243], v[244:247]
    v_mfma_f32_16x16x32_bf16 v[248:251], v[208:211], v[240:243], v[248:251]
    ds_read_b128 v[148:151], v93 offset:0
    ds_read_b128 v[152:155], v93 offset:16
    ds_read_b128 v[156:159], v93 offset:32
    s_nop 3
    s_nop 0
    v_cvt_pk_bf16_f32 v212, v244, v245
    v_cvt_pk_bf16_f32 v213, v246, v247
    v_cvt_pk_bf16_f32 v214, v248, v249
    v_cvt_pk_bf16_f32 v215, v250, v251
    ds_write_b16 v88, v212
    ds_write_b16_d16_hi v89, v212
    ds_write_b16 v90, v213
    ds_write_b16_d16_hi v91, v213
    s_mov_b32 exec_hi, 0
    ds_write_b16 v92, v214 offset:2560
    s_mov_b32 exec_lo, 0xffff
    ds_write_b16_d16_hi v92, v214 offset:3200
    ds_write_b16 v92, v215 offset:3840
    ds_write_b16_d16_hi v92, v215 offset:4480
    s_mov_b64 exec, -1
    s_waitcnt lgkmcnt(0)
    s_barrier
    ds_read_u16 v216, v148 offset:0
    ds_read_u16 v217, v149 offset:0
    ds_read_u16 v218, v150 offset:0
    ds_read_u16 v219, v151 offset:0
    ds_read_u16 v220, v152 offset:0
    ds_read_u16 v221, v153 offset:0
    ds_read_u16 v222, v154 offset:0
    ds_read_u16 v223, v155 offset:0
    ds_read_u16 v224, v156 offset:0
    ds_read_u16 v225, v157 offset:0
    ds_read_u16 v226, v158 offset:0
    ds_read_u16 v227, v159 offset:0
    ds_read_u16 v228, v148 offset:5776
    ds_read_u16 v229, v149 offset:5776
    ds_read_u16 v230, v150 offset:5776
    ds_read_u16 v231, v151 offset:5776
    ds_read_u16 v232, v152 offset:5776
    ds_read_u16 v233, v153 offset:5776
    ds_read_u16 v234, v154 offset:5776
    ds_read_u16 v235, v155 offset:5776
    ds_read_u16 v236, v156 offset:5776
    ds_read_u16 v237, v157 offset:5776
    ds_read_u16 v238, v158 offset:5776
    ds_read_u16 v239, v159 offset:5776
    v_add_u32 v12, 89440, v1
    s_waitcnt lgkmcnt(12)
    s_nop 0
    v_lshl_or_b32 v192, v217, 16, v216
    v_lshl_or_b32 v193, v219, 16, v218
    v_lshl_or_b32 v194, v221, 16, v220
    v_lshl_or_b32 v195, v223, 16, v222
    v_lshl_or_b32 v196, v225, 16, v224
    v_lshl_or_b32 v197, v227, 16, v226
    v_alignbit_b32 v176, v194, v193, 16
    v_alignbit_b32 v177, v195, v194, 16
    v_alignbit_b32 v178, v196, v195, 16
    v_alignbit_b32 v179, v197, v196, 16
    v_mov_b32 v180, v193
    v_mov_b32 v181, v194
    v_mov_b32 v182, v195
    v_mov_b32 v183, v196
    v_alignbit_b32 v184, v193, v192, 16
    v_alignbit_b32 v185, v194, v193, 16
    v_alignbit_b32 v186, v195, v194, 16
    v_alignbit_b32 v187, v196, v195, 16
    ds_write_b128 v12, v[194:197] offset:0
    ds_write_b128 v12, v[176:179] offset:4160
    ds_write_b128 v12, v[180:183] offset:8320
    ds_write_b128 v12, v[184:187] offset:12480
    s_mov_b64 exec, s[90:91]
    buffer_load_dwordx4 v[120:123], v2, s[12:15], s72 offen sc1
    buffer_load_dwordx4 v[124:127], v3, s[12:15], s72 offen sc1
    s_mov_b64 exec, s[92:93]
    buffer_load_dwordx4 v[144:147], v2, s[12:15], s74 offen sc1
    s_mov_b64 exec, -1
    s_waitcnt lgkmcnt(4)
    v_lshl_or_b32 v198, v229, 16, v228
    v_lshl_or_b32 v199, v231, 16, v230
    v_lshl_or_b32 v200, v233, 16, v232
    v_lshl_or_b32 v201, v235, 16, v234
    v_lshl_or_b32 v202, v237, 16, v236
    v_lshl_or_b32 v203, v239, 16, v238
    s_branch L_expand1
L_expand:
    v_add_u32 v12, 89440, v1
    v_alignbit_b32 v176, v194, v193, 16
    v_alignbit_b32 v177, v195, v194, 16
    v_alignbit_b32 v178, v196, v195, 16
    v_alignbit_b32 v179, v197, v196, 16
    v_mov_b32 v180, v193
    v_mov_b32 v181, v194
    v_mov_b32 v182, v195
    v_mov_b32_e64 v183, v196
    v_alignbit_b32 v184, v193, v192, 16
    v_alignbit_b32 v185, v194, v193, 16
    v_alignbit_b32 v186, v195, v194, 16
    v_alignbit_b32 v187, v196, v195, 16
    ds_write_b128 v12, v[194:197] offset:0
    ds_write_b128 v12, v[176:179] offset:4160
    ds_write_b128 v12, v[180:183] offset:8320
    ds_write_b128 v12, v[184:187] offset:12480
L_expand1:
    v_alignbit_b32 v228, v200, v199, 16
    v_alignbit_b32 v229, v201, v200, 16
    v_alignbit_b32 v230, v202, v201, 16
    v_alignbit_b32 v231, v203, v202, 16
    v_mov_b32 v232, v199
    v_mov_b32 v233, v200
    v_mov_b32 v234, v201
    v_mov_b32 v235, v202
    v_alignbit_b32 v236, v199, v198, 16
    v_alignbit_b32 v237, v200, v199, 16
    v_alignbit_b32 v238, v201, v200, 16
    v_alignbit_b32 v239, v202, v201, 16
    ds_write_b128 v12, v[200:203] offset:16640
    ds_write_b128 v12, v[228:231] offset:20800
    ds_write_b128 v12, v[232:235] offset:24960
    ds_write_b128 v12, v[236:239] offset:29120
    s_setpc_b64 s[60:61]
L_kfrag:
    s_waitcnt lgkmcnt(0)
    s_barrier
    s_nop 0
    ds_read_b64_tr_b16 a[0:1], v6 offset:32
    ds_read_b64_tr_b16 a[2:3], v6 offset:0
    ds_read_b64_tr_b16 a[64:65], v6 offset:4192
    ds_read_b64_tr_b16 a[66:67], v6 offset:4160
    ds_read_b64_tr_b16 a[128:129], v6 offset:8352
    ds_read_b64_tr_b16 a[130:131], v6 offset:8320
    ds_read_b64_tr_b16 a[192:193], v6 offset:12512
    ds_read_b64_tr_b16 a[194:195], v6 offset:12480
    ds_read_b64_tr_b16 a[4:5], v6 offset:288
    ds_read_b64_tr_b16 a[6:7], v6 offset:256
    ds_read_b64_tr_b16 a[68:69], v6 offset:4448
    ds_read_b64_tr_b16 a[70:71], v6 offset:4416
    ds_read_b64_tr_b16 a[132:133], v6 offset:8608
    ds_read_b64_tr_b16 a[134:135], v6 offset:8576
    ds_read_b64_tr_b16 a[196:197], v6 offset:12768
    ds_read_b64_tr_b16 a[198:199], v6 offset:12736
    ds_read_b64_tr_b16 a[8:9], v6 offset:544
    ds_read_b64_tr_b16 a[10:11], v6 offset:512
    ds_read_b64_tr_b16 a[72:73], v6 offset:4704
    ds_read_b64_tr_b16 a[74:75], v6 offset:4672
    ds_read_b64_tr_b16 a[136:137], v6 offset:8864
    ds_read_b64_tr_b16 a[138:139], v6 offset:8832
    ds_read_b64_tr_b16 a[200:201], v6 offset:13024
    ds_read_b64_tr_b16 a[202:203], v6 offset:12992
    ds_read_b64_tr_b16 a[12:13], v6 offset:800
    ds_read_b64_tr_b16 a[14:15], v6 offset:768
    ds_read_b64_tr_b16 a[76:77], v6 offset:4960
    ds_read_b64_tr_b16 a[78:79], v6 offset:4928
    ds_read_b64_tr_b16 a[140:141], v6 offset:9120
    ds_read_b64_tr_b16 a[142:143], v6 offset:9088
    ds_read_b64_tr_b16 a[204:205], v6 offset:13280
    ds_read_b64_tr_b16 a[206:207], v6 offset:13248
    ds_read_b64_tr_b16 a[16:17], v6 offset:1056
    ds_read_b64_tr_b16 a[18:19], v6 offset:1024
    ds_read_b64_tr_b16 a[80:81], v6 offset:5216
    ds_read_b64_tr_b16 a[82:83], v6 offset:5184
    ds_read_b64_tr_b16 a[144:145], v6 offset:9376
    ds_read_b64_tr_b16 a[146:147], v6 offset:9344
    ds_read_b64_tr_b16 a[208:209], v6 offset:13536
    ds_read_b64_tr_b16 a[210:211], v6 offset:13504
    ds_read_b64_tr_b16 a[20:21], v6 offset:1312
    ds_read_b64_tr_b16 a[22:23], v6 offset:1280
    ds_read_b64_tr_b16 a[84:85], v6 offset:5472
    ds_read_b64_tr_b16 a[86:87], v6 offset:5440
    ds_read_b64_tr_b16 a[148:149], v6 offset:9632
    ds_read_b64_tr_b16 a[150:151], v6 offset:9600
    ds_read_b64_tr_b16 a[212:213], v6 offset:13792
    ds_read_b64_tr_b16 a[214:215], v6 offset:13760
    ds_read_b64_tr_b16 a[24:25], v6 offset:1568
    ds_read_b64_tr_b16 a[26:27], v6 offset:1536
    ds_read_b64_tr_b16 a[88:89], v6 offset:5728
    ds_read_b64_tr_b16 a[90:91], v6 offset:5696
    ds_read_b64_tr_b16 a[152:153], v6 offset:9888
    ds_read_b64_tr_b16 a[154:155], v6 offset:9856
    ds_read_b64_tr_b16 a[216:217], v6 offset:14048
    ds_read_b64_tr_b16 a[218:219], v6 offset:14016
    ds_read_b64_tr_b16 a[28:29], v6 offset:1824
    ds_read_b64_tr_b16 a[30:31], v6 offset:1792
    ds_read_b64_tr_b16 a[92:93], v6 offset:5984
    ds_read_b64_tr_b16 a[94:95], v6 offset:5952
    ds_read_b64_tr_b16 a[156:157], v6 offset:10144
    ds_read_b64_tr_b16 a[158:159], v6 offset:10112
    ds_read_b64_tr_b16 a[220:221], v6 offset:14304
    ds_read_b64_tr_b16 a[222:223], v6 offset:14272
    s_cmp_lg_u32 s77, 0
    s_cbranch_scc1 L_kfrag_end
    ds_read_b64_tr_b16 a[32:33], v6 offset:2080
    ds_read_b64_tr_b16 a[34:35], v6 offset:2048
    ds_read_b64_tr_b16 a[96:97], v6 offset:6240
    ds_read_b64_tr_b16 a[98:99], v6 offset:6208
    ds_read_b64_tr_b16 a[160:161], v6 offset:10400
    ds_read_b64_tr_b16 a[162:163], v6 offset:10368
    ds_read_b64_tr_b16 a[224:225], v6 offset:14560
    ds_read_b64_tr_b16 a[226:227], v6 offset:14528
    ds_read_b64_tr_b16 a[36:37], v6 offset:2336
    ds_read_b64_tr_b16 a[38:39], v6 offset:2304
    ds_read_b64_tr_b16 a[100:101], v6 offset:6496
    ds_read_b64_tr_b16 a[102:103], v6 offset:6464
    ds_read_b64_tr_b16 a[164:165], v6 offset:10656
    ds_read_b64_tr_b16 a[166:167], v6 offset:10624
    ds_read_b64_tr_b16 a[228:229], v6 offset:14816
    ds_read_b64_tr_b16 a[230:231], v6 offset:14784
L_kfrag_end:
    s_setpc_b64 s[60:61]
L_r6:
    s_mov_b32 s8, s46
    s_mov_b32 s9, s47
    s_add_u32 s57, s79, 4096
    v_lshlrev_b32 v14, 1, v0
    s_cmp_eq_u32 s6, 0
    s_cbranch_scc1 L_nosl6_25
    s_sleep 12
    buffer_load_dwordx4 v[120:123], v2, s[12:15], s72 offen sc1
    buffer_load_dwordx4 v[124:127], v3, s[12:15], s72 offen sc1
    s_waitcnt vmcnt(0)
L_nosl6_25:
    s_waitcnt vmcnt(1)
L_r6_chk_26:
    v_max3_u32 v12, v120, v121, v122
    v_max3_u32 v12, v12, v123, v124
    v_max3_u32 v12, v12, v125, v126
    v_max_u32 v12, v12, v127
    v_cmp_eq_u32 vcc, -1, v12
    s_nop 0
    s_cbranch_vccnz L_r6_rt_27
L_r6_ok_28:
    s_nop 0
    v_dot2_f32_bf16 v88, v120, s64, v48
    v_dot2_f32_bf16 v89, v124, s64, v49
    v_dot2_f32_bf16 v90, v120, s65, v50
    v_dot2_f32_bf16 v91, v124, s65, v51
    v_dot2_f32_bf16 v92, v121, s64, v52
    v_dot2_f32_bf16 v93, v125, s64, v53
    v_dot2_f32_bf16 v94, v121, s65, v54
    v_dot2_f32_bf16 v95, v125, s65, v55
    v_dot2_f32_bf16 v96, v122, s64, v56
    v_dot2_f32_bf16 v97, v126, s64, v57
    v_dot2_f32_bf16 v98, v122, s65, v58
    v_dot2_f32_bf16 v99, v126, s65, v59
    v_dot2_f32_bf16 v100, v123, s64, v60
    v_dot2_f32_bf16 v101, v127, s64, v61
    v_dot2_f32_bf16 v102, v123, s65, v62
    v_dot2_f32_bf16 v103, v127, s65, v63
    v_cvt_pk_bf16_f32 v80, v88, v89
    v_cvt_pk_bf16_f32 v81, v90, v91
    v_cvt_pk_bf16_f32 v82, v92, v93
    v_cvt_pk_bf16_f32 v83, v94, v95
    v_cvt_pk_bf16_f32 v84, v96, v97
    v_cvt_pk_bf16_f32 v85, v98, v99
    v_cvt_pk_bf16_f32 v86, v100, v101
    v_cvt_pk_bf16_f32 v87, v102, v103
    buffer_store_short v80, v14, s[8:11], s79 offen offset:0 nt
    buffer_store_short_d16_hi v80, v14, s[8:11], s79 offen offset:512 nt
    buffer_store_short v81, v14, s[8:11], s79 offen offset:1024 nt
    buffer_store_short_d16_hi v81, v14, s[8:11], s79 offen offset:1536 nt
    buffer_store_short v82, v14, s[8:11], s79 offen offset:2048 nt
    buffer_store_short_d16_hi v82, v14, s[8:11], s79 offen offset:2560 nt
    buffer_store_short v83, v14, s[8:11], s79 offen offset:3072 nt
    buffer_store_short_d16_hi v83, v14, s[8:11], s79 offen offset:3584 nt
    buffer_store_short v84, v14, s[8:11], s57 offen offset:0 nt
    buffer_store_short_d16_hi v84, v14, s[8:11], s57 offen offset:512 nt
    buffer_store_short v85, v14, s[8:11], s57 offen offset:1024 nt
    buffer_store_short_d16_hi v85, v14, s[8:11], s57 offen offset:1536 nt
    buffer_store_short v86, v14, s[8:11], s57 offen offset:2048 nt
    buffer_store_short_d16_hi v86, v14, s[8:11], s57 offen offset:2560 nt
    buffer_store_short v87, v14, s[8:11], s57 offen offset:3072 nt
    buffer_store_short_d16_hi v87, v14, s[8:11], s57 offen offset:3584 nt
L_exit:
    s_endpgm
L_arr1:
    v_mov_b32 v92, -1
    v_mov_b32 v93, -1
    v_mov_b32 v94, -1
    v_mov_b32 v95, -1
    s_add_u32 s82, s81, 2097152
    buffer_store_dwordx4 v[92:95], v1, s[12:15], s82 offen sc1
    buffer_store_dwordx4 v[92:95], v11, s[12:15], s82 offen sc1
    s_and_b32 s57, s2, 63
    s_lshl_b32 s57, s57, 2
    v_mov_b32 v12, 1
    v_mov_b32 v13, 0
    s_mov_b64 exec, 1
    buffer_atomic_add v12, v13, s[52:55], s57 offen sc1
    s_mov_b64 exec, -1
    s_branch L_arr1_ret
L_g0:
    s_waitcnt vmcnt(7)
    s_branch L_g0r
L_d1_rt_4:
    s_sub_u32 s69, s69, 1
    s_cselect_b32 s69, 0x100000, s69
    s_cbranch_scc1 L_d1_ok_5
    s_sleep 14
    buffer_load_dword v148, v149, s[52:55], 0 offen sc1
    s_waitcnt vmcnt(0)
    s_branch L_d1_chk_3
L_c_rt_7:
    s_sub_u32 s69, s69, 1
    s_cselect_b32 s69, 0x100000, s69
    s_cbranch_scc1 L_c_ok_8
    s_sleep 1
    s_mov_b64 exec, vcc
    buffer_load_dwordx4 v[144:147], v2, s[12:15], s74 offen sc1
    buffer_load_dwordx4 v[120:123], v3, s[12:15], s74 offen sc1
    s_mov_b64 exec, -1
    s_waitcnt vmcnt(0)
    s_branch L_c_chk_6
L_r2_rt_10:
    s_sub_u32 s69, s69, 1
    s_cselect_b32 s69, 0x100000, s69
    s_cbranch_scc1 L_r2_ok_11
    s_sleep 1
    s_mov_b64 exec, vcc
    buffer_load_dwordx4 v[120:123], v2, s[12:15], s72 offen sc1
    buffer_load_dwordx4 v[124:127], v3, s[12:15], s72 offen sc1
    s_mov_b64 exec, -1
    s_waitcnt vmcnt(0)
    s_branch L_r2_chk_9
L_c_rt_14:
    s_sub_u32 s69, s69, 1
    s_cselect_b32 s69, 0x100000, s69
    s_cbranch_scc1 L_c_ok_15
    s_sleep 1
    s_mov_b64 exec, vcc
    buffer_load_dwordx4 v[144:147], v2, s[12:15], s74 offen sc1
    s_mov_b64 exec, -1
    s_waitcnt vmcnt(0)
    s_branch L_c_chk_13
L_h0_rt_16:
    s_sub_u32 s69, s69, 1
    s_cselect_b32 s69, 0x100000, s69
    s_cbranch_scc1 L_h0_ok_17
    s_sleep 1
    s_mov_b64 exec, vcc
    buffer_load_dwordx4 v[144:147], v2, s[12:15], s74 offen sc1
    s_mov_b64 exec, -1
    s_waitcnt vmcnt(0)
    v_max3_u32 v12, v144, v145, v146
    v_max_u32 v12, v12, v147
    v_cmp_eq_u32 vcc, -1, v12
    s_nop 0
    s_cbranch_vccnz L_h0_rt_16
    s_branch L_h0_ok_17
L_h1_rt_18:
    s_sub_u32 s69, s69, 1
    s_cselect_b32 s69, 0x100000, s69
    s_cbranch_scc1 L_h1_ok_19
    s_sleep 1
    s_mov_b64 exec, vcc
    buffer_load_dwordx4 v[144:147], v2, s[12:15], s74 offen sc1
    s_mov_b64 exec, -1
    s_waitcnt vmcnt(0)
    v_max3_u32 v12, v144, v145, v146
    v_max_u32 v12, v12, v147
    v_cmp_eq_u32 vcc, -1, v12
    s_nop 0
    s_cbranch_vccnz L_h1_rt_18
    s_branch L_h1_ok_19
L_r4_rt_22:
    s_sub_u32 s69, s69, 1
    s_cselect_b32 s69, 0x100000, s69
    s_cbranch_scc1 L_r4_ok_23
    s_sleep 1
    s_mov_b64 exec, vcc
    buffer_load_dwordx4 v[120:123], v2, s[12:15], s72 offen sc1
    buffer_load_dwordx4 v[124:127], v3, s[12:15], s72 offen sc1
    s_mov_b64 exec, -1
    s_waitcnt vmcnt(0)
    s_branch L_r4_chk_21
L_r6_rt_27:
    s_sub_u32 s69, s69, 1
    s_cselect_b32 s69, 0x100000, s69
    s_cbranch_scc1 L_r6_ok_28
    s_sleep 1
    s_mov_b64 exec, vcc
    buffer_load_dwordx4 v[120:123], v2, s[12:15], s72 offen sc1
    buffer_load_dwordx4 v[124:127], v3, s[12:15], s72 offen sc1
    s_mov_b64 exec, -1
    s_waitcnt vmcnt(0)
    s_branch L_r6_chk_26
L_end:
    s_endpgm
.section .rodata,"a"
.p2align 6
.amdhsa_kernel interleave_layers__ssm_conv_h3__ssm_conv_s4__prompt_kernel
  .amdhsa_next_free_vgpr 512
  .amdhsa_next_free_sgpr 96
  .amdhsa_accum_offset 256
  .amdhsa_group_segment_fixed_size 0
  .amdhsa_kernarg_size 144
  .amdhsa_user_sgpr_count 2
  .amdhsa_user_sgpr_kernarg_segment_ptr 1
  .amdhsa_system_sgpr_workgroup_id_x 1
.end_amdhsa_kernel
```
